```python
import torch

def _softmax(x, axis=-1):
    return torch.softmax(x, dim=axis)
def _gelu(x):
    return torch.nn.functional.gelu(x, approximate="tanh")
def _silu(x):
    return torch.nn.functional.silu(x)
def _sigmoid(x):
    return torch.sigmoid(x)
def _layernorm(x, axis=-1, eps=1e-5):
    m = x.mean(dim=axis, keepdim=True)
    v = x.var(dim=axis, keepdim=True, unbiased=False)
    return (x - m) / torch.sqrt(v + eps)
def _scatter_add(tgt, idx, src, axis=0):
    return tgt.clone().index_add_(axis, idx, src)
def _segment_sum(src, seg, n):
    out = torch.zeros((n,) + src.shape[1:], dtype=src.dtype)
    return out.index_add_(0, seg, src)
def _pad(x, pw):
    flat = tuple(v for pair in reversed(pw) for v in pair)
    return torch.nn.functional.pad(x, flat)

kernel_name = 'gated_mix__ssm_conv_s5__glu_gated_bilinear__prompt'

def setup_inputs():

    _w = (lambda a: (lambda t: t.to(torch.bfloat16) if t.is_floating_point() else t)(torch.as_tensor(a)))
    def _A_setup():
        B, S, D = 1, 2048, 448
        P = D
        Lambda_re = -0.5 * (lambda _x: torch.exp(torch.as_tensor(_x)))((lambda *s: torch.randn(*s, dtype=torch.bfloat16) * 0.2)(P))
        Lambda_im = (lambda *s: torch.randn(*s, dtype=torch.bfloat16) * 0.4)(P) * 1.0
        B_re = (lambda *s: torch.randn(*s, dtype=torch.bfloat16) * 0.2)(P, D) * (D ** -0.5)
        B_im = (lambda *s: torch.randn(*s, dtype=torch.bfloat16) * 0.2)(P, D) * (D ** -0.5)
        C_re = (lambda *s: torch.randn(*s, dtype=torch.bfloat16) * 0.2)(D, P) * (P ** -0.5)
        C_im = (lambda *s: torch.randn(*s, dtype=torch.bfloat16) * 0.2)(D, P) * (P ** -0.5)
        log_dt = (lambda *s: torch.randn(*s, dtype=torch.bfloat16) * 0.2)(P) * 0.3 - 2.0
        Dskip = (lambda *s: torch.randn(*s, dtype=torch.bfloat16) * 0.05)(D)
        return {
            "x": _w((lambda *s: torch.randn(*s, dtype=torch.bfloat16) * 0.05)(B, S, D)),
            "Lambda_re": _w(Lambda_re),
            "Lambda_im": _w(Lambda_im),
            "B_re": _w(B_re),
            "B_im": _w(B_im),
            "C_re": _w(C_re),
            "C_im": _w(C_im),
            "log_dt": _w(log_dt),
            "Dskip": _w(Dskip),
        }
    _A_in = _A_setup()

    def _B_setup():
        B, S, D, F = 1, 2048, 448, 1792
        return {
            "x": _w((lambda *s: torch.randn(*s, dtype=torch.bfloat16) * 0.05)(B, S, D)),
            "w_gate": _w((lambda *s: torch.randn(*s, dtype=torch.bfloat16) * 0.8)(D, F) * (D ** -0.5)),
            "w_up": _w((lambda *s: torch.randn(*s, dtype=torch.bfloat16) * 0.8)(D, F) * (D ** -0.5)),
            "w_down": _w((lambda *s: torch.randn(*s, dtype=torch.bfloat16) * 0.8)(F, D) * (F ** -0.5)),
        }
    _B_in = _B_setup()

    return {
        "A_x": _A_in["x"],
        "A_Lambda_re": _A_in["Lambda_re"],
        "A_Lambda_im": _A_in["Lambda_im"],
        "A_B_re": _A_in["B_re"],
        "A_B_im": _A_in["B_im"],
        "A_C_re": _A_in["C_re"],
        "A_C_im": _A_in["C_im"],
        "A_log_dt": _A_in["log_dt"],
        "A_Dskip": _A_in["Dskip"],
        "B_x": _B_in["x"],
        "B_w_gate": _B_in["w_gate"],
        "B_w_up": _B_in["w_up"],
        "B_w_down": _B_in["w_down"],
        "gate_w": _w((lambda *s: torch.randn(*s, dtype=torch.bfloat16) * 0.05)(448) * 16.0),
    }

def reference(A_x, A_Lambda_re, A_Lambda_im, A_B_re, A_B_im, A_C_re, A_C_im, A_log_dt, A_Dskip, B_x, B_w_gate, B_w_up, B_w_down, gate_w):
    def _A_ref(x, Lambda_re, Lambda_im, B_re, B_im, C_re, C_im, log_dt, Dskip):
        Bsz, L, H = x.shape
        Lam = Lambda_re + 1j * Lambda_im
        Bmat = B_re + 1j * B_im
        Cmat = C_re + 1j * C_im
        dt = torch.exp(log_dt)
        Lam_bar = torch.exp(dt * Lam)
        B_bar = ((Lam_bar - 1.0) / Lam)[:, None] * Bmat
        Bu = torch.einsum("bld,pd->blp", x + 0j, B_bar)
        h = torch.zeros_like(Bu[:, 0, :])
        hs = []
        for t in range(L):
            h = Lam_bar[None, :] * h + Bu[:, t, :]
            hs.append(h)
        hseq = torch.stack(hs, 1)
        y = 2.0 * torch.einsum("blp,dp->bld", hseq, Cmat).real + x * Dskip[None, None, :]
        return y

    def _B_ref(x, w_gate, w_up, w_down):
        g = torch.einsum("bsd,df->bsf", x, w_gate)
        u = torch.einsum("bsd,df->bsf", x, w_up)
        h = g * u
        return torch.einsum("bsf,fd->bsd", h, w_down)

    x = A_x
    g = _sigmoid((x * gate_w).sum(-1, keepdims=True))
    a = _A_ref(x, A_Lambda_re, A_Lambda_im, A_B_re, A_B_im, A_C_re, A_C_im, A_log_dt, A_Dskip)
    b = _B_ref(x, B_w_gate, B_w_up, B_w_down)
    return g * a + (1 - g) * b
```

```asm
; @launch grid=(256,1,1) block=(256,1,1) lds=163840
.amdgcn_target "amdgcn-amd-amdhsa--gfx950"
.text
.globl gated_mix__ssm_conv_s5__glu_gated_bilinear__prompt_kernel
.p2align 8
.type gated_mix__ssm_conv_s5__glu_gated_bilinear__prompt_kernel,@function
gated_mix__ssm_conv_s5__glu_gated_bilinear__prompt_kernel:
    s_load_dwordx16 s[68:83], s[0:1], 0
    s_load_dwordx16 s[84:99], s[0:1], 64
    s_load_dwordx2 s[100:101], s[0:1], 128
    s_cmp_ge_u32 s2, 256
    s_cbranch_scc1 L_end
    s_getpc_b64 s[62:63]
L_pc:
    s_and_b32 s3, s2, 0xf8
    v_and_b32 v1, 7, v0
    v_add_lshl_u32 v1, v1, s3, 7
    v_min_u32 v1, L_last-L_pc-4, v1
    global_load_dword v64, v1, s[62:63]
    v_lshrrev_b32 v1, 6, v0
    s_and_b32 s3, s2, 7
    v_readfirstlane_b32 s44, v1
    s_lshr_b32 s53, s2, 3
    s_cmp_lt_u32 s53, 4
    s_cbranch_scc1 L_helper
    s_sub_u32 s53, s53, 4
    s_mul_i32 s54, s53, 9363
    s_lshr_b32 s54, s54, 16
    s_mul_i32 s47, s54, 7
    s_sub_u32 s47, s53, s47
    s_and_b32 s48, s3, 1
    s_lshr_b32 s45, s3, 1
    s_lshl2_add_u32 s45, s54, s45
    s_mul_i32 s46, s48, 7
    s_add_u32 s46, s46, s47
    s_lshl_b32 s50, s44, 10
    s_lshl_b32 s52, s44, 12
    s_lshl_b32 s56, s47, 7
    v_and_b32 v196, 63, v0
    v_lshrrev_b32 v197, 3, v196
    v_and_b32 v198, 7, v196
    v_lshrrev_b32 v199, 4, v196
    s_lshl2_add_u32 s53, s45, s44
    s_mul_i32 s53, s53, 28672
    v_mul_u32_u24 v200, 896, v197
    v_xor_b32 v201, v198, v199
    v_lshl_add_u32 v30, v201, 4, v200
    v_and_b32 v205, 1, v199
    v_xor_b32 v201, v198, v205
    v_lshl_add_u32 v201, v201, 4, v200
    s_and_b32 s49, s44, 1
    s_lshl_b32 s55, s49, 6
    v_xor_b32 v201, s55, v201
    v_add_u32 v176, s53, v201
    v_add_u32 v177, 6144, v176
    v_xor_b32 v201, 32, v176
    v_add_u32 v178, 12288, v201
    v_add_u32 v179, 18432, v201
    v_xor_b32 v180, s55, v30
    s_lshl2_add_u32 s55, s46, s44
    s_mul_i32 s55, s55, 7168
    v_add_u32 v180, s55, v180
    s_mov_b32 s6, 0x1c0000
    s_mov_b32 s7, 0x20000
    s_mov_b32 s10, 0x62000
    s_mov_b32 s11, 0x20000
    s_mov_b32 s14, 0x62000
    s_mov_b32 s15, 0x20000
    s_add_u32 m0, s52, 0
    s_waitcnt lgkmcnt(0)
    s_mov_b64 s[4:5], s[68:69]
    buffer_load_dwordx4 v176, s[4:7], s56 offen lds
    buffer_load_dwordx4 v177, s[4:7], s56 offen offset:1024 lds
    buffer_load_dwordx4 v178, s[4:7], s56 offen offset:2048 lds
    buffer_load_dwordx4 v179, s[4:7], s56 offen offset:3072 lds
    s_add_u32 m0, s50, 147456
    s_mov_b64 s[8:9], s[74:75]
    buffer_load_dwordx4 v180, s[8:11], s56 offen lds
    s_add_u32 m0, s50, 151552
    s_mov_b64 s[12:13], s[76:77]
    buffer_load_dwordx4 v180, s[12:15], s56 offen lds
    v_and_b32 v202, 31, v196
    v_lshrrev_b32 v204, 5, v196
    v_and_b32 v203, 15, v196
    s_lshr_b32 s54, s44, 1
    s_lshl1_add_u32 s53, s46, s54
    s_lshl_b32 s53, s53, 5
    v_lshl_add_u32 v200, v203, 1, s53
    global_load_ushort v190, v200, s[70:71]
    global_load_ushort v191, v200, s[72:73]
    global_load_ushort v192, v200, s[82:83]
    s_cmp_eq_u32 s49, 0
    s_cselect_b64 s[0:1], s[74:75], s[76:77]
    s_cselect_b64 s[64:65], s[88:89], s[90:91]
    s_lshl4_add_u32 s53, s46, s45
    s_mul_i32 s53, s53, 1792
    s_mul_i32 s54, s45, 392
    s_add_u32 s54, s54, s46
    s_lshl_b32 s54, s54, 8
    s_cmp_lt_u32 s44, 2
    s_cselect_b64 s[0:1], s[0:1], s[64:65]
    s_cselect_b32 s53, s53, s54
    s_cselect_b32 s54, 13, 0
    s_cselect_b32 s55, 1, 28
    s_cselect_b32 s64, 0, 0
    v_min_u32 v200, s54, v202
    v_mul_u32_u24 v200, s55, v200
    v_and_b32 v201, s64, v204
    v_add_u32 v200, v200, v201
    v_lshl_add_u32 v200, v200, 7, s53
    global_load_dword v244, v200, s[0:1]
    s_add_u32 s57, s56, 128
    s_cmp_eq_u32 s57, 896
    s_cselect_b32 s57, 0, s57
    s_add_u32 m0, s52, 16384
    s_nop 0
    buffer_load_dwordx4 v176, s[4:7], s57 offen lds
    s_mov_b64 s[16:17], s[88:89]
    s_mov_b32 s18, 0x188000
    s_mov_b32 s19, 0x20000
    s_mov_b64 s[20:21], s[90:91]
    s_mov_b32 s22, 0x188000
    s_mov_b32 s23, 0x20000
    s_mov_b64 s[24:25], s[92:93]
    s_mov_b32 s26, 0x188000
    s_mov_b32 s27, 0x20000
    s_cmp_eq_u32 s48, 0
    s_cselect_b64 s[28:29], s[78:79], s[80:81]
    s_mov_b32 s30, 0x62000
    s_mov_b32 s31, 0x20000
    s_mov_b64 s[32:33], s[100:101]
    s_mov_b32 s34, 0x10000000
    s_mov_b32 s35, 0x20000
    s_mov_b64 s[36:37], s[96:97]
    s_mov_b32 s38, 0x380000
    s_mov_b32 s39, 0x20000
    s_mov_b64 s[86:87], s[84:85]
    s_mov_b64 s[88:89], s[98:99]
    s_lshl_b32 s51, s44, 11
    s_lshr_b32 s70, s44, 1
    s_add_u32 s58, s57, 128
    s_cmp_eq_u32 s58, 896
    s_cselect_b32 s58, 0, s58
    s_add_u32 s59, s58, 128
    s_cmp_eq_u32 s59, 896
    s_cselect_b32 s59, 0, s59
    s_add_u32 s60, s59, 128
    s_cmp_eq_u32 s60, 896
    s_cselect_b32 s60, 0, s60
    s_add_u32 s61, s60, 128
    s_cmp_eq_u32 s61, 896
    s_cselect_b32 s61, 0, s61
    s_add_u32 s62, s61, 128
    s_cmp_eq_u32 s62, 896
    s_cselect_b32 s62, 0, s62
    v_bfe_u32 v186, v196, 2, 2
    v_and_b32 v187, 3, v196
    v_lshrrev_b32 v200, 1, v203
    v_xor_b32 v200, v200, v199
    v_lshlrev_b32 v200, 4, v200
    s_lshl_b32 s53, s49, 6
    v_lshl_add_u32 v189, v186, 4, s53
    v_add_u32 v189, v189, v187
    v_lshl_add_u32 v182, v189, 7, v200
    v_xor_b32 v183, 64, v182
    s_lshl_b32 s53, s70, 11
    s_add_u32 s53, s53, 0x18000
    v_lshl_add_u32 v200, v203, 7, v200
    v_add_u32 v184, s53, v200
    v_xor_b32 v185, 64, v184
    s_mov_b64 exec, 0
    s_cmp_eq_u32 s44, 0
    s_cbranch_scc1 L_pg0
    s_cmp_eq_u32 s44, 1
    s_cbranch_scc1 L_pg1
    s_cmp_eq_u32 s44, 2
    s_cbranch_scc1 L_pg2
    s_branch L_pg3
L_back:
    s_mov_b64 exec, -1
    v_lshlrev_b32 v1, 4, v196
    buffer_load_dwordx4 v177, s[4:7], s57 offen offset:1024 lds
    s_mul_i32 s63, s56, 1792
    s_mul_i32 s64, s57, 1792
    s_mul_i32 s65, s58, 1792
    s_mul_i32 s66, s59, 1792
    s_mul_i32 s67, s60, 1792
    s_mul_i32 s68, s61, 1792
    s_mul_i32 s69, s62, 1792
    v_lshlrev_b32 v200, 1, v205
    v_xor_b32 v200, v200, v198
    v_mul_u32_u24 v201, 3584, v197
    v_lshl_add_u32 v5, v200, 4, v201
    s_mul_i32 s55, s44, 224
    s_add_u32 s55, s55, s46
    buffer_load_dwordx4 v178, s[4:7], s57 offen offset:2048 lds
    s_lshl_b32 s55, s55, 8
    v_add_u32 v5, s55, v5
    v_xor_b32 v6, 64, v5
    v_add_u32 v6, 27648, v6
    s_lshl2_add_u32 s55, s47, s44
    s_mul_i32 s55, s55, 14336
    v_add_u32 v30, s55, v30
    v_xor_b32 v31, 64, v30
    v_add_u32 v31, 6144, v31
    v_lshlrev_b32 v200, 2, v205
    v_xor_b32 v200, v200, v198
    v_mul_u32_u24 v201, 896, v197
    v_lshl_add_u32 v26, v200, 4, v201
    buffer_load_dwordx4 v179, s[4:7], s57 offen offset:3072 lds
    s_mul_i32 s55, s48, 28
    s_add_u32 s55, s55, s70
    s_lshl2_add_u32 s55, s55, s49
    s_mul_i32 s55, s55, 56
    s_add_u32 s55, s55, s47
    s_lshl_b32 s55, s55, 7
    v_add_u32 v26, s55, v26
    v_add_u32 v27, 13312, v26
    v_add_u32 v28, 55296, v26
    v_add_u32 v29, 68608, v26
    v_mov_b32 v224, 0
    v_mov_b32 v225, 0
    s_lshl_b32 s55, s44, 9
    s_add_u32 m0, s50, 139264
    s_add_u32 s55, s55, 157696
    v_lshl_add_u32 v200, v196, 3, s55
    ds_write_b64 v200, v[224:225]
    s_lshl_b32 s55, s49, 2
    v_add_u32 v253, s55, v199
    v_lshrrev_b32 v188, 1, v186
    v_lshl_add_u32 v200, v205, 1, v188
    s_and_b32 s55, s44, 2
    v_xor_b32 v200, s55, v200
    v_lshlrev_b32 v200, 5, v200
    v_lshl_add_u32 v200, v187, 3, v200
    v_lshl_add_u32 v201, v199, 3, v186
    v_lshl_add_u32 v3, v201, 7, v200
    buffer_load_dwordx4 v180, s[8:11], s57 offen lds
    v_xor_b32 v4, 32, v3
    v_add_u32 v24, 0x10000, v3
    v_add_u32 v25, 0x10000, v4
    v_and_b32 v200, 1, v187
    v_lshlrev_b32 v200, 4, v200
    v_mov_b32 v201, 0x3f80
    v_lshlrev_b32 v200, v200, v201
    v_cmp_eq_u32 vcc, v199, v186
    s_nop 1
    v_cndmask_b32 v200, 0, v200, vcc
    v_cmp_gt_u32 vcc, 2, v187
    s_nop 1
    v_cndmask_b32 v44, 0, v200, vcc
    v_cndmask_b32 v45, v200, 0, vcc
    v_lshl_add_u32 v200, v188, 1, v205
    s_add_u32 m0, s50, 143360
    v_lshl_add_u32 v200, v200, 5, s52
    v_lshl_add_u32 v200, v187, 3, v200
    v_lshl_add_u32 v201, v204, 2, v186
    v_lshl_add_u32 v32, v201, 7, v200
    v_xor_b32 v33, 64, v32
    v_bfe_u32 v200, v202, 1, 3
    s_lshl_b32 s55, s44, 1
    v_xor_b32 v200, v200, v204
    v_xor_b32 v200, s55, v200
    v_lshlrev_b32 v200, 4, v200
    v_lshl_add_u32 v34, v202, 7, v200
    v_add_u32 v34, 0x18000, v34
    s_lshl_b32 s55, s70, 7
    buffer_load_dwordx4 v180, s[12:15], s57 offen lds
    v_lshl_add_u32 v201, v203, 3, s55
    v_lshl_add_u32 v23, v253, 8, v201
    v_add_u32 v23, 157696, v23
    v_lshlrev_b32 v39, 2, v189
    v_add_u32 v39, 156160, v39
    v_lshlrev_b32 v251, 6, v253
    v_add_u32 v251, 155648, v251
    s_lshl_b32 s55, s44, 7
    s_add_u32 s55, s55, 155648
    v_lshl_add_u32 v8, v202, 2, s55
    v_lshl_add_u32 v8, v204, 9, v8
    v_mul_u32_u24 v7, 3072, v204
    v_lshl_add_u32 v7, v205, 9, v7
    v_lshl_add_u32 v7, v203, 4, v7
    v_bfrev_b32 v200, 1
    v_mov_b32 v35, 1
    v_add_u32 v188, s50, v196
    v_cmp_gt_u32 vcc, 1, v188
    v_lshlrev_b32 v254, 2, v196
    s_lshl_b32 s85, s45, 8
    v_cndmask_b32 v2, v200, v1, vcc
    v_cmp_eq_u32 vcc, 7, v253
    s_cmp_eq_u32 s44, 3
    s_cselect_b32 s95, 1, 3
    s_cselect_b32 s101, 15, 0
    v_cndmask_b32 v40, v200, v201, vcc
    v_lshlrev_b32 v188, 6, v196
    s_mov_b32 s100, 15
    s_mov_b32 vcc_hi, 0
    s_mov_b32 vcc_lo, s101
    v_cndmask_b32 v255, v200, v188, vcc
    v_lshlrev_b32 v188, 7, v196
    s_mov_b32 vcc_lo, s95
    v_cndmask_b32 v42, v200, v188, vcc
    s_mov_b32 vcc_lo, 15
    v_cndmask_b32 v43, v200, v188, vcc
    s_sub_u32 s55, s85, 256
    v_lshlrev_b32 v200, 9, v253
    v_sub_u32 v41, v201, v200
    v_add_u32 v41, s55, v41
    s_lshl1_add_u32 s77, s45, s49
    s_mul_i32 s77, s77, 344064
    s_lshl1_add_u32 s55, s46, s70
    s_mul_i32 s79, s55, 3072
    s_lshl1_add_u32 s55, s79, s77
    s_add_u32 s79, s79, s77
    s_mov_b32 s77, s55
    s_add_u32 s78, s77, 172032
    s_lshl_b32 s54, s45, 11
    s_add_u32 s54, s54, 16842752
    s_lshl3_add_u32 s55, s48, s47
    s_lshl_b32 s55, s55, 7
    s_add_u32 s80, s55, s54
    s_lshl2_add_u32 s55, s48, s44
    s_lshl_b32 s55, s55, 8
    s_add_u32 s81, s54, s55
    s_lshl_b32 s55, s44, 9
    s_add_u32 s82, s54, s55
    s_add_u32 s82, s82, 32768
    s_lshl2_add_u32 s71, s45, s44
    s_lshl_b32 s71, s71, 7
    s_add_u32 s71, s71, 16834560
    s_mul_i32 s54, s45, 14
    s_add_u32 s84, s54, s46
    s_mul_i32 s84, s84, 8192
    s_add_u32 s84, s84, 12582912
    v_add_u32 v252, s51, v1
    s_mul_i32 s55, s48, -114688
    s_add_u32 s83, s84, s55
    s_add_u32 s83, s83, 57344
    s_mul_i32 s54, s48, 28
    s_add_u32 s54, s54, s44
    s_mul_i32 s54, s54, 3072
    s_lshl1_add_u32 s55, s45, s48
    s_mul_i32 s93, s55, 344064
    s_add_u32 s93, s93, s54
    s_xor_b32 s55, s55, 1
    s_mul_i32 s91, s55, 344064
    s_add_u32 s91, s91, s54
    s_add_u32 s92, s91, 172032
    s_add_u32 s94, s93, 172032
    v_xor_b32 v200, v198, v204
    s_lshl_b32 s55, s44, 13
    v_lshl_add_u32 v200, v200, 4, s55
    v_lshl_add_u32 v201, v186, 1, v205
    v_lshl_add_u32 v201, v201, 2, v187
    v_lshl_add_u32 v46, v201, 8, v200
    v_xor_b32 v200, v203, v253
    v_lshl_add_u32 v200, v200, 4, s51
    v_lshl_add_u32 v47, v199, 8, v200
    s_lshl2_add_u32 s55, s48, s44
    s_lshl_b32 s55, s55, 4
    v_add_u32 v200, s55, v199
    v_lshlrev_b32 v249, 2, v200
    v_add_u32 v249, 155648, v249
    s_lshl_b32 s55, s45, 7
    v_add_u32 v200, s55, v200
    v_mul_u32_u24 v200, 896, v200
    s_lshl_b32 s55, s47, 7
    v_lshl_add_u32 v250, v203, 3, s55
    v_add_u32 v248, v200, v250
    s_lshl_b32 s55, s46, 12
    s_add_u32 s55, s55, 16777216
    s_add_u32 s40, s32, s55
    s_addc_u32 s41, s33, 0
    s_mov_b32 s42, 4096
    s_mov_b32 s43, 0x20000
    s_branch L_body
L_helper:
    s_lshl3_add_u32 s3, s53, s3
    v_and_b32 v16, 63, v0
    v_lshlrev_b32 v17, 4, v0
    v_bfrev_b32 v3, 1
    v_mov_b32 v8, 0
    v_mov_b32 v9, 1
    v_mov_b32 v4, -1
    v_mov_b32 v5, -1
    v_mov_b32 v6, -1
    v_mov_b32 v7, -1
    s_cmp_lt_u32 s44, 2
    s_cbranch_scc1 L_hgate
    s_and_b32 s50, s44, 1
    s_mul_i32 s51, s50, 112
    v_add_u32 v1, s51, v16
    v_cmp_gt_u32 vcc, 56, v16
    v_lshlrev_b32 v2, 8, v1
    v_lshlrev_b32 v1, 7, v1
    v_cndmask_b32 v2, v3, v2, vcc
    v_cndmask_b32 v18, v3, v1, vcc
    v_lshlrev_b32 v19, 4, v16
    s_sub_u32 s51, s3, 4
    s_mul_i32 s54, s51, 57344
    s_add_u32 s56, s54, 14336
    s_lshr_b32 s55, s51, 1
    s_mul_i32 s55, s55, 28672
    s_add_u32 s57, s55, 7168
    v_lshrrev_b32 v14, 7, v1
    v_mul_u32_u24 v15, 9363, v14
    v_lshrrev_b32 v15, 16, v15
    v_mul_u32_u24 v15, 7, v15
    v_add_lshl_u32 v14, v14, v15, 8
    v_cndmask_b32 v14, v3, v14, vcc
    s_lshr_b32 s51, s51, 1
    s_and_b32 s52, s3, 1
    s_mul_i32 s64, s51, 114688
    s_mul_i32 s65, s52, 1792
    s_add_u32 s64, s64, s65
    s_add_u32 s65, s64, 28672
    s_mul_i32 s52, s52, 14
    s_add_u32 s51, s51, s52
    s_mul_i32 s54, s51, 57344
    s_add_u32 s56, s54, 14336
    s_mul_i32 s52, s3, 16384
    s_add_u32 s52, s52, 16777216
    s_waitcnt lgkmcnt(0)
    s_mov_b64 s[32:33], s[100:101]
    s_mov_b32 s34, 0x10000000
    s_mov_b32 s35, 0x20000
    s_cmp_ge_u32 s3, 4
    s_cbranch_scc1 L_noinit
    s_lshl_b32 s50, s50, 5
    s_add_u32 s50, s50, s3
    s_cmp_ge_u32 s50, 4
    s_cbranch_scc1 L_idone
    buffer_store_dwordx4 v[4:7], v19, s[32:35], s52 offen offset:0 sc1
    buffer_store_dwordx4 v[4:7], v19, s[32:35], s52 offen offset:1024 sc1
    buffer_store_dwordx4 v[4:7], v19, s[32:35], s52 offen offset:2048 sc1
    buffer_store_dwordx4 v[4:7], v19, s[32:35], s52 offen offset:3072 sc1
    s_add_u32 s52, s52, 4096
    buffer_store_dwordx4 v[4:7], v19, s[32:35], s52 offen offset:0 sc1
    buffer_store_dwordx4 v[4:7], v19, s[32:35], s52 offen offset:1024 sc1
    buffer_store_dwordx4 v[4:7], v19, s[32:35], s52 offen offset:2048 sc1
    buffer_store_dwordx4 v[4:7], v19, s[32:35], s52 offen offset:3072 sc1
    s_add_u32 s52, s52, 4096
    buffer_store_dwordx4 v[4:7], v19, s[32:35], s52 offen offset:0 sc1
    buffer_store_dwordx4 v[4:7], v19, s[32:35], s52 offen offset:1024 sc1
    buffer_store_dwordx4 v[4:7], v19, s[32:35], s52 offen offset:2048 sc1
    buffer_store_dwordx4 v[4:7], v19, s[32:35], s52 offen offset:3072 sc1
    s_add_u32 s52, s52, 4096
    buffer_store_dwordx4 v[4:7], v19, s[32:35], s52 offen offset:0 sc1
    buffer_store_dwordx4 v[4:7], v19, s[32:35], s52 offen offset:1024 sc1
    buffer_store_dwordx4 v[4:7], v19, s[32:35], s52 offen offset:2048 sc1
    buffer_store_dwordx4 v[4:7], v19, s[32:35], s52 offen offset:3072 sc1
    s_mov_b64 s[40:41], s[98:99]
    s_mov_b32 s42, 0x100
    s_mov_b32 s43, 0x20000
    v_cmp_gt_u32 vcc, 4, v16
    s_mul_i32 s52, s3, 64
    s_nop 0
    v_cndmask_b32 v19, v3, v19, vcc
    s_waitcnt vmcnt(0)
    buffer_store_dwordx4 v[4:7], v19, s[40:43], s52 offen sc1
L_idone:
    s_branch L_hmb
L_noinit:
    s_barrier
    s_bitcmp0_b32 s3, 0
    s_cselect_b64 s[28:29], s[78:79], s[80:81]
    s_cselect_b64 s[8:9], s[74:75], s[76:77]
    s_mov_b32 s30, 0x62000
    s_mov_b32 s31, 0x20000
    s_mov_b32 s10, 0x62000
    s_mov_b32 s11, 0x20000
    s_mov_b64 s[24:25], s[92:93]
    s_mov_b32 s26, 0x188000
    s_mov_b32 s27, 0x20000
    s_mov_b64 s[16:17], s[88:89]
    s_mov_b32 s18, 0x188000
    s_mov_b32 s19, 0x20000
    s_mov_b64 s[20:21], s[90:91]
    s_mov_b32 s22, 0x188000
    s_mov_b32 s23, 0x20000
    buffer_load_dword v22, v14, s[16:19], s64 offen offset:0
    buffer_load_dword v23, v14, s[16:19], s65 offen offset:0
    buffer_load_dword v24, v14, s[20:23], s64 offen offset:0
    buffer_load_dword v25, v14, s[20:23], s65 offen offset:0
    s_waitcnt vmcnt(3)
    buffer_load_dword v26, v18, s[28:31], s55 offen offset:0
    s_waitcnt vmcnt(3)
    buffer_load_dword v27, v18, s[28:31], s57 offen offset:0
    s_waitcnt vmcnt(3)
    buffer_load_dword v28, v14, s[16:19], s64 offen offset:128
    s_waitcnt vmcnt(3)
    buffer_load_dword v29, v14, s[16:19], s65 offen offset:128
    s_waitcnt vmcnt(3)
    buffer_load_dword v30, v14, s[20:23], s64 offen offset:128
    s_waitcnt vmcnt(3)
    buffer_load_dword v31, v14, s[20:23], s65 offen offset:128
    s_waitcnt vmcnt(3)
    buffer_load_dword v32, v2, s[24:27], s54 offen offset:0
    s_waitcnt vmcnt(3)
    buffer_load_dword v33, v2, s[24:27], s56 offen offset:0
    s_waitcnt vmcnt(3)
    buffer_load_dword v34, v2, s[24:27], s54 offen offset:128
    s_waitcnt vmcnt(3)
    buffer_load_dword v35, v2, s[24:27], s56 offen offset:128
    s_mov_b64 s[40:41], s[84:85]
    s_mov_b32 s42, 0x380
    s_mov_b32 s43, 0x20000
    buffer_load_dword v11, v19, s[40:43], 0 offen
    s_branch L_hmb
L_hgate:
    v_and_b32 v32, 7, v0
    v_lshlrev_b32 v32, 4, v32
    v_lshrrev_b32 v33, 3, v16
    v_mul_u32_u24 v34, 3584, v33
    v_add_u32 v34, v34, v32
    s_lshl1_add_u32 s50, s3, s44
    s_mul_i32 s60, s50, 28672
    s_add_u32 s61, s60, 896
    s_add_u32 s62, s60, 1792
    s_add_u32 s63, s60, 2688
    s_waitcnt lgkmcnt(0)
    s_mov_b64 s[4:5], s[68:69]
    s_mov_b32 s6, 0x1c0000
    s_mov_b32 s7, 0x20000
    s_mov_b64 s[32:33], s[100:101]
    s_mov_b32 s34, 0x10000000
    s_mov_b32 s35, 0x20000
    global_load_dwordx4 v[40:43], v32, s[94:95] offset:0
    global_load_dwordx4 v[44:47], v32, s[94:95] offset:128
    global_load_dwordx4 v[48:51], v32, s[94:95] offset:256
    global_load_dwordx4 v[52:55], v32, s[94:95] offset:384
    global_load_dwordx4 v[56:59], v32, s[94:95] offset:512
    global_load_dwordx4 v[60:63], v32, s[94:95] offset:640
    global_load_dwordx4 v[64:67], v32, s[94:95] offset:768
    buffer_load_dwordx4 v[128:131], v34, s[4:7], s60 offen offset:0
    buffer_load_dwordx4 v[156:159], v34, s[4:7], s61 offen offset:0
    buffer_load_dwordx4 v[184:187], v34, s[4:7], s62 offen offset:0
    buffer_load_dwordx4 v[212:215], v34, s[4:7], s63 offen offset:0
    buffer_load_dwordx4 v[132:135], v34, s[4:7], s60 offen offset:128
    buffer_load_dwordx4 v[160:163], v34, s[4:7], s61 offen offset:128
    buffer_load_dwordx4 v[188:191], v34, s[4:7], s62 offen offset:128
    buffer_load_dwordx4 v[216:219], v34, s[4:7], s63 offen offset:128
    buffer_load_dwordx4 v[136:139], v34, s[4:7], s60 offen offset:256
    buffer_load_dwordx4 v[164:167], v34, s[4:7], s61 offen offset:256
    buffer_load_dwordx4 v[192:195], v34, s[4:7], s62 offen offset:256
    buffer_load_dwordx4 v[220:223], v34, s[4:7], s63 offen offset:256
    buffer_load_dwordx4 v[140:143], v34, s[4:7], s60 offen offset:384
    buffer_load_dwordx4 v[168:171], v34, s[4:7], s61 offen offset:384
    buffer_load_dwordx4 v[196:199], v34, s[4:7], s62 offen offset:384
    buffer_load_dwordx4 v[224:227], v34, s[4:7], s63 offen offset:384
    buffer_load_dwordx4 v[144:147], v34, s[4:7], s60 offen offset:512
    buffer_load_dwordx4 v[172:175], v34, s[4:7], s61 offen offset:512
    buffer_load_dwordx4 v[200:203], v34, s[4:7], s62 offen offset:512
    buffer_load_dwordx4 v[228:231], v34, s[4:7], s63 offen offset:512
    buffer_load_dwordx4 v[148:151], v34, s[4:7], s60 offen offset:640
    buffer_load_dwordx4 v[176:179], v34, s[4:7], s61 offen offset:640
    buffer_load_dwordx4 v[204:207], v34, s[4:7], s62 offen offset:640
    buffer_load_dwordx4 v[232:235], v34, s[4:7], s63 offen offset:640
    buffer_load_dwordx4 v[152:155], v34, s[4:7], s60 offen offset:768
    buffer_load_dwordx4 v[180:183], v34, s[4:7], s61 offen offset:768
    buffer_load_dwordx4 v[208:211], v34, s[4:7], s62 offen offset:768
    buffer_load_dwordx4 v[236:239], v34, s[4:7], s63 offen offset:768
    v_and_b32 v11, 31, v16
    v_lshlrev_b32 v11, 4, v11
    v_lshrrev_b32 v12, 5, v16
    v_lshl_add_u32 v12, v12, 15, v11
    s_lshl_b32 s51, s50, 9
    s_add_u32 s51, s51, 16842752
    s_add_u32 s52, s51, 65536
    buffer_store_dwordx4 v[4:7], v12, s[32:35], s51 offen sc1
    buffer_store_dwordx4 v[4:7], v11, s[32:35], s52 offen sc1
    v_lshlrev_b32 v12, 2, v16
    s_cmp_lt_u32 s3, 4
    s_cbranch_scc1 L_nob
    s_barrier
L_nob:
    s_waitcnt vmcnt(36)
    v_and_b32 v73, 0xffff0000, v40
    v_and_b32 v72, 0xffff, v40
    v_and_b32 v75, 0xffff0000, v41
    v_and_b32 v74, 0xffff, v41
    v_and_b32 v77, 0xffff0000, v42
    v_and_b32 v76, 0xffff, v42
    v_and_b32 v79, 0xffff0000, v43
    v_and_b32 v78, 0xffff, v43
    s_waitcnt vmcnt(35)
    v_and_b32 v81, 0xffff0000, v44
    v_and_b32 v80, 0xffff, v44
    v_and_b32 v83, 0xffff0000, v45
    v_and_b32 v82, 0xffff, v45
    v_and_b32 v85, 0xffff0000, v46
    v_and_b32 v84, 0xffff, v46
    v_and_b32 v87, 0xffff0000, v47
    v_and_b32 v86, 0xffff, v47
    s_waitcnt vmcnt(34)
    v_and_b32 v89, 0xffff0000, v48
    v_and_b32 v88, 0xffff, v48
    v_and_b32 v91, 0xffff0000, v49
    v_and_b32 v90, 0xffff, v49
    v_and_b32 v93, 0xffff0000, v50
    v_and_b32 v92, 0xffff, v50
    v_and_b32 v95, 0xffff0000, v51
    v_and_b32 v94, 0xffff, v51
    s_waitcnt vmcnt(33)
    v_and_b32 v97, 0xffff0000, v52
    v_and_b32 v96, 0xffff, v52
    v_and_b32 v99, 0xffff0000, v53
    v_and_b32 v98, 0xffff, v53
    v_and_b32 v101, 0xffff0000, v54
    v_and_b32 v100, 0xffff, v54
    v_and_b32 v103, 0xffff0000, v55
    v_and_b32 v102, 0xffff, v55
    s_waitcnt vmcnt(32)
    v_and_b32 v105, 0xffff0000, v56
    v_and_b32 v104, 0xffff, v56
    v_and_b32 v107, 0xffff0000, v57
    v_and_b32 v106, 0xffff, v57
    v_and_b32 v109, 0xffff0000, v58
    v_and_b32 v108, 0xffff, v58
    v_and_b32 v111, 0xffff0000, v59
    v_and_b32 v110, 0xffff, v59
    s_waitcnt vmcnt(31)
    v_and_b32 v113, 0xffff0000, v60
    v_and_b32 v112, 0xffff, v60
    v_and_b32 v115, 0xffff0000, v61
    v_and_b32 v114, 0xffff, v61
    v_and_b32 v117, 0xffff0000, v62
    v_and_b32 v116, 0xffff, v62
    v_and_b32 v119, 0xffff0000, v63
    v_and_b32 v118, 0xffff, v63
    s_waitcnt vmcnt(30)
    v_and_b32 v121, 0xffff0000, v64
    v_and_b32 v120, 0xffff, v64
    v_and_b32 v123, 0xffff0000, v65
    v_and_b32 v122, 0xffff, v65
    v_and_b32 v125, 0xffff0000, v66
    v_and_b32 v124, 0xffff, v66
    v_and_b32 v127, 0xffff0000, v67
    v_and_b32 v126, 0xffff, v67
    v_mov_b32 v35, 0x3f803f80
    v_mov_b32 v36, 0
    v_mov_b32 v37, 0
    v_mov_b32 v38, 0
    v_mov_b32 v39, 0
    s_waitcnt vmcnt(29)
    v_dot2_f32_bf16 v40, v128, v72, 0
    s_waitcnt vmcnt(28)
    v_dot2_f32_bf16 v42, v156, v72, 0
    s_waitcnt vmcnt(27)
    v_dot2_f32_bf16 v44, v184, v72, 0
    s_waitcnt vmcnt(26)
    v_dot2_f32_bf16 v46, v212, v72, 0
    v_dot2_f32_bf16 v41, v128, v73, 0
    v_dot2_f32_bf16 v43, v156, v73, 0
    v_dot2_f32_bf16 v45, v184, v73, 0
    v_dot2_f32_bf16 v47, v212, v73, 0
    v_cvt_pk_bf16_f32 v40, v40, v41
    v_cvt_pk_bf16_f32 v42, v42, v43
    v_cvt_pk_bf16_f32 v44, v44, v45
    v_cvt_pk_bf16_f32 v46, v46, v47
    v_dot2c_f32_bf16 v36, v40, v35
    v_dot2c_f32_bf16 v37, v42, v35
    v_dot2c_f32_bf16 v38, v44, v35
    v_dot2c_f32_bf16 v39, v46, v35
    v_dot2_f32_bf16 v40, v129, v74, 0
    v_dot2_f32_bf16 v42, v157, v74, 0
    v_dot2_f32_bf16 v44, v185, v74, 0
    v_dot2_f32_bf16 v46, v213, v74, 0
    v_dot2_f32_bf16 v41, v129, v75, 0
    v_dot2_f32_bf16 v43, v157, v75, 0
    v_dot2_f32_bf16 v45, v185, v75, 0
    v_dot2_f32_bf16 v47, v213, v75, 0
    v_cvt_pk_bf16_f32 v40, v40, v41
    v_cvt_pk_bf16_f32 v42, v42, v43
    v_cvt_pk_bf16_f32 v44, v44, v45
    v_cvt_pk_bf16_f32 v46, v46, v47
    v_dot2c_f32_bf16 v36, v40, v35
    v_dot2c_f32_bf16 v37, v42, v35
    v_dot2c_f32_bf16 v38, v44, v35
    v_dot2c_f32_bf16 v39, v46, v35
    v_dot2_f32_bf16 v40, v130, v76, 0
    v_dot2_f32_bf16 v42, v158, v76, 0
    v_dot2_f32_bf16 v44, v186, v76, 0
    v_dot2_f32_bf16 v46, v214, v76, 0
    v_dot2_f32_bf16 v41, v130, v77, 0
    v_dot2_f32_bf16 v43, v158, v77, 0
    v_dot2_f32_bf16 v45, v186, v77, 0
    v_dot2_f32_bf16 v47, v214, v77, 0
    v_cvt_pk_bf16_f32 v40, v40, v41
    v_cvt_pk_bf16_f32 v42, v42, v43
    v_cvt_pk_bf16_f32 v44, v44, v45
    v_cvt_pk_bf16_f32 v46, v46, v47
    v_dot2c_f32_bf16 v36, v40, v35
    v_dot2c_f32_bf16 v37, v42, v35
    v_dot2c_f32_bf16 v38, v44, v35
    v_dot2c_f32_bf16 v39, v46, v35
    v_dot2_f32_bf16 v40, v131, v78, 0
    v_dot2_f32_bf16 v42, v159, v78, 0
    v_dot2_f32_bf16 v44, v187, v78, 0
    v_dot2_f32_bf16 v46, v215, v78, 0
    v_dot2_f32_bf16 v41, v131, v79, 0
    v_dot2_f32_bf16 v43, v159, v79, 0
    v_dot2_f32_bf16 v45, v187, v79, 0
    v_dot2_f32_bf16 v47, v215, v79, 0
    v_cvt_pk_bf16_f32 v40, v40, v41
    v_cvt_pk_bf16_f32 v42, v42, v43
    v_cvt_pk_bf16_f32 v44, v44, v45
    v_cvt_pk_bf16_f32 v46, v46, v47
    v_dot2c_f32_bf16 v36, v40, v35
    v_dot2c_f32_bf16 v37, v42, v35
    v_dot2c_f32_bf16 v38, v44, v35
    v_dot2c_f32_bf16 v39, v46, v35
    s_waitcnt vmcnt(25)
    v_dot2_f32_bf16 v40, v132, v80, 0
    s_waitcnt vmcnt(24)
    v_dot2_f32_bf16 v42, v160, v80, 0
    s_waitcnt vmcnt(23)
    v_dot2_f32_bf16 v44, v188, v80, 0
    s_waitcnt vmcnt(22)
    v_dot2_f32_bf16 v46, v216, v80, 0
    v_dot2_f32_bf16 v41, v132, v81, 0
    v_dot2_f32_bf16 v43, v160, v81, 0
    v_dot2_f32_bf16 v45, v188, v81, 0
    v_dot2_f32_bf16 v47, v216, v81, 0
    v_cvt_pk_bf16_f32 v40, v40, v41
    v_cvt_pk_bf16_f32 v42, v42, v43
    v_cvt_pk_bf16_f32 v44, v44, v45
    v_cvt_pk_bf16_f32 v46, v46, v47
    v_dot2c_f32_bf16 v36, v40, v35
    v_dot2c_f32_bf16 v37, v42, v35
    v_dot2c_f32_bf16 v38, v44, v35
    v_dot2c_f32_bf16 v39, v46, v35
    v_dot2_f32_bf16 v40, v133, v82, 0
    v_dot2_f32_bf16 v42, v161, v82, 0
    v_dot2_f32_bf16 v44, v189, v82, 0
    v_dot2_f32_bf16 v46, v217, v82, 0
    v_dot2_f32_bf16 v41, v133, v83, 0
    v_dot2_f32_bf16 v43, v161, v83, 0
    v_dot2_f32_bf16 v45, v189, v83, 0
    v_dot2_f32_bf16 v47, v217, v83, 0
    v_cvt_pk_bf16_f32 v40, v40, v41
    v_cvt_pk_bf16_f32 v42, v42, v43
    v_cvt_pk_bf16_f32 v44, v44, v45
    v_cvt_pk_bf16_f32 v46, v46, v47
    v_dot2c_f32_bf16 v36, v40, v35
    v_dot2c_f32_bf16 v37, v42, v35
    v_dot2c_f32_bf16 v38, v44, v35
    v_dot2c_f32_bf16 v39, v46, v35
    v_dot2_f32_bf16 v40, v134, v84, 0
    v_dot2_f32_bf16 v42, v162, v84, 0
    v_dot2_f32_bf16 v44, v190, v84, 0
    v_dot2_f32_bf16 v46, v218, v84, 0
    v_dot2_f32_bf16 v41, v134, v85, 0
    v_dot2_f32_bf16 v43, v162, v85, 0
    v_dot2_f32_bf16 v45, v190, v85, 0
    v_dot2_f32_bf16 v47, v218, v85, 0
    v_cvt_pk_bf16_f32 v40, v40, v41
    v_cvt_pk_bf16_f32 v42, v42, v43
    v_cvt_pk_bf16_f32 v44, v44, v45
    v_cvt_pk_bf16_f32 v46, v46, v47
    v_dot2c_f32_bf16 v36, v40, v35
    v_dot2c_f32_bf16 v37, v42, v35
    v_dot2c_f32_bf16 v38, v44, v35
    v_dot2c_f32_bf16 v39, v46, v35
    v_dot2_f32_bf16 v40, v135, v86, 0
    v_dot2_f32_bf16 v42, v163, v86, 0
    v_dot2_f32_bf16 v44, v191, v86, 0
    v_dot2_f32_bf16 v46, v219, v86, 0
    v_dot2_f32_bf16 v41, v135, v87, 0
    v_dot2_f32_bf16 v43, v163, v87, 0
    v_dot2_f32_bf16 v45, v191, v87, 0
    v_dot2_f32_bf16 v47, v219, v87, 0
    v_cvt_pk_bf16_f32 v40, v40, v41
    v_cvt_pk_bf16_f32 v42, v42, v43
    v_cvt_pk_bf16_f32 v44, v44, v45
    v_cvt_pk_bf16_f32 v46, v46, v47
    v_dot2c_f32_bf16 v36, v40, v35
    v_dot2c_f32_bf16 v37, v42, v35
    v_dot2c_f32_bf16 v38, v44, v35
    v_dot2c_f32_bf16 v39, v46, v35
    s_waitcnt vmcnt(21)
    v_dot2_f32_bf16 v40, v136, v88, 0
    s_waitcnt vmcnt(20)
    v_dot2_f32_bf16 v42, v164, v88, 0
    s_waitcnt vmcnt(19)
    v_dot2_f32_bf16 v44, v192, v88, 0
    s_waitcnt vmcnt(18)
    v_dot2_f32_bf16 v46, v220, v88, 0
    v_dot2_f32_bf16 v41, v136, v89, 0
    v_dot2_f32_bf16 v43, v164, v89, 0
    v_dot2_f32_bf16 v45, v192, v89, 0
    v_dot2_f32_bf16 v47, v220, v89, 0
    v_cvt_pk_bf16_f32 v40, v40, v41
    v_cvt_pk_bf16_f32 v42, v42, v43
    v_cvt_pk_bf16_f32 v44, v44, v45
    v_cvt_pk_bf16_f32 v46, v46, v47
    v_dot2c_f32_bf16 v36, v40, v35
    v_dot2c_f32_bf16 v37, v42, v35
    v_dot2c_f32_bf16 v38, v44, v35
    v_dot2c_f32_bf16 v39, v46, v35
    v_dot2_f32_bf16 v40, v137, v90, 0
    v_dot2_f32_bf16 v42, v165, v90, 0
    v_dot2_f32_bf16 v44, v193, v90, 0
    v_dot2_f32_bf16 v46, v221, v90, 0
    v_dot2_f32_bf16 v41, v137, v91, 0
    v_dot2_f32_bf16 v43, v165, v91, 0
    v_dot2_f32_bf16 v45, v193, v91, 0
    v_dot2_f32_bf16 v47, v221, v91, 0
    v_cvt_pk_bf16_f32 v40, v40, v41
    v_cvt_pk_bf16_f32 v42, v42, v43
    v_cvt_pk_bf16_f32 v44, v44, v45
    v_cvt_pk_bf16_f32 v46, v46, v47
    v_dot2c_f32_bf16 v36, v40, v35
    v_dot2c_f32_bf16 v37, v42, v35
    v_dot2c_f32_bf16 v38, v44, v35
    v_dot2c_f32_bf16 v39, v46, v35
    v_dot2_f32_bf16 v40, v138, v92, 0
    v_dot2_f32_bf16 v42, v166, v92, 0
    v_dot2_f32_bf16 v44, v194, v92, 0
    v_dot2_f32_bf16 v46, v222, v92, 0
    v_dot2_f32_bf16 v41, v138, v93, 0
    v_dot2_f32_bf16 v43, v166, v93, 0
    v_dot2_f32_bf16 v45, v194, v93, 0
    v_dot2_f32_bf16 v47, v222, v93, 0
    v_cvt_pk_bf16_f32 v40, v40, v41
    v_cvt_pk_bf16_f32 v42, v42, v43
    v_cvt_pk_bf16_f32 v44, v44, v45
    v_cvt_pk_bf16_f32 v46, v46, v47
    v_dot2c_f32_bf16 v36, v40, v35
    v_dot2c_f32_bf16 v37, v42, v35
    v_dot2c_f32_bf16 v38, v44, v35
    v_dot2c_f32_bf16 v39, v46, v35
    v_dot2_f32_bf16 v40, v139, v94, 0
    v_dot2_f32_bf16 v42, v167, v94, 0
    v_dot2_f32_bf16 v44, v195, v94, 0
    v_dot2_f32_bf16 v46, v223, v94, 0
    v_dot2_f32_bf16 v41, v139, v95, 0
    v_dot2_f32_bf16 v43, v167, v95, 0
    v_dot2_f32_bf16 v45, v195, v95, 0
    v_dot2_f32_bf16 v47, v223, v95, 0
    v_cvt_pk_bf16_f32 v40, v40, v41
    v_cvt_pk_bf16_f32 v42, v42, v43
    v_cvt_pk_bf16_f32 v44, v44, v45
    v_cvt_pk_bf16_f32 v46, v46, v47
    v_dot2c_f32_bf16 v36, v40, v35
    v_dot2c_f32_bf16 v37, v42, v35
    v_dot2c_f32_bf16 v38, v44, v35
    v_dot2c_f32_bf16 v39, v46, v35
    s_waitcnt vmcnt(17)
    v_dot2_f32_bf16 v40, v140, v96, 0
    s_waitcnt vmcnt(16)
    v_dot2_f32_bf16 v42, v168, v96, 0
    s_waitcnt vmcnt(15)
    v_dot2_f32_bf16 v44, v196, v96, 0
    s_waitcnt vmcnt(14)
    v_dot2_f32_bf16 v46, v224, v96, 0
    v_dot2_f32_bf16 v41, v140, v97, 0
    v_dot2_f32_bf16 v43, v168, v97, 0
    v_dot2_f32_bf16 v45, v196, v97, 0
    v_dot2_f32_bf16 v47, v224, v97, 0
    v_cvt_pk_bf16_f32 v40, v40, v41
    v_cvt_pk_bf16_f32 v42, v42, v43
    v_cvt_pk_bf16_f32 v44, v44, v45
    v_cvt_pk_bf16_f32 v46, v46, v47
    v_dot2c_f32_bf16 v36, v40, v35
    v_dot2c_f32_bf16 v37, v42, v35
    v_dot2c_f32_bf16 v38, v44, v35
    v_dot2c_f32_bf16 v39, v46, v35
    v_dot2_f32_bf16 v40, v141, v98, 0
    v_dot2_f32_bf16 v42, v169, v98, 0
    v_dot2_f32_bf16 v44, v197, v98, 0
    v_dot2_f32_bf16 v46, v225, v98, 0
    v_dot2_f32_bf16 v41, v141, v99, 0
    v_dot2_f32_bf16 v43, v169, v99, 0
    v_dot2_f32_bf16 v45, v197, v99, 0
    v_dot2_f32_bf16 v47, v225, v99, 0
    v_cvt_pk_bf16_f32 v40, v40, v41
    v_cvt_pk_bf16_f32 v42, v42, v43
    v_cvt_pk_bf16_f32 v44, v44, v45
    v_cvt_pk_bf16_f32 v46, v46, v47
    v_dot2c_f32_bf16 v36, v40, v35
    v_dot2c_f32_bf16 v37, v42, v35
    v_dot2c_f32_bf16 v38, v44, v35
    v_dot2c_f32_bf16 v39, v46, v35
    v_dot2_f32_bf16 v40, v142, v100, 0
    v_dot2_f32_bf16 v42, v170, v100, 0
    v_dot2_f32_bf16 v44, v198, v100, 0
    v_dot2_f32_bf16 v46, v226, v100, 0
    v_dot2_f32_bf16 v41, v142, v101, 0
    v_dot2_f32_bf16 v43, v170, v101, 0
    v_dot2_f32_bf16 v45, v198, v101, 0
    v_dot2_f32_bf16 v47, v226, v101, 0
    v_cvt_pk_bf16_f32 v40, v40, v41
    v_cvt_pk_bf16_f32 v42, v42, v43
    v_cvt_pk_bf16_f32 v44, v44, v45
    v_cvt_pk_bf16_f32 v46, v46, v47
    v_dot2c_f32_bf16 v36, v40, v35
    v_dot2c_f32_bf16 v37, v42, v35
    v_dot2c_f32_bf16 v38, v44, v35
    v_dot2c_f32_bf16 v39, v46, v35
    v_dot2_f32_bf16 v40, v143, v102, 0
    v_dot2_f32_bf16 v42, v171, v102, 0
    v_dot2_f32_bf16 v44, v199, v102, 0
    v_dot2_f32_bf16 v46, v227, v102, 0
    v_dot2_f32_bf16 v41, v143, v103, 0
    v_dot2_f32_bf16 v43, v171, v103, 0
    v_dot2_f32_bf16 v45, v199, v103, 0
    v_dot2_f32_bf16 v47, v227, v103, 0
    v_cvt_pk_bf16_f32 v40, v40, v41
    v_cvt_pk_bf16_f32 v42, v42, v43
    v_cvt_pk_bf16_f32 v44, v44, v45
    v_cvt_pk_bf16_f32 v46, v46, v47
    v_dot2c_f32_bf16 v36, v40, v35
    v_dot2c_f32_bf16 v37, v42, v35
    v_dot2c_f32_bf16 v38, v44, v35
    v_dot2c_f32_bf16 v39, v46, v35
    s_waitcnt vmcnt(13)
    v_dot2_f32_bf16 v40, v144, v104, 0
    s_waitcnt vmcnt(12)
    v_dot2_f32_bf16 v42, v172, v104, 0
    s_waitcnt vmcnt(11)
    v_dot2_f32_bf16 v44, v200, v104, 0
    s_waitcnt vmcnt(10)
    v_dot2_f32_bf16 v46, v228, v104, 0
    v_dot2_f32_bf16 v41, v144, v105, 0
    v_dot2_f32_bf16 v43, v172, v105, 0
    v_dot2_f32_bf16 v45, v200, v105, 0
    v_dot2_f32_bf16 v47, v228, v105, 0
    v_cvt_pk_bf16_f32 v40, v40, v41
    v_cvt_pk_bf16_f32 v42, v42, v43
    v_cvt_pk_bf16_f32 v44, v44, v45
    v_cvt_pk_bf16_f32 v46, v46, v47
    v_dot2c_f32_bf16 v36, v40, v35
    v_dot2c_f32_bf16 v37, v42, v35
    v_dot2c_f32_bf16 v38, v44, v35
    v_dot2c_f32_bf16 v39, v46, v35
    v_dot2_f32_bf16 v40, v145, v106, 0
    v_dot2_f32_bf16 v42, v173, v106, 0
    v_dot2_f32_bf16 v44, v201, v106, 0
    v_dot2_f32_bf16 v46, v229, v106, 0
    v_dot2_f32_bf16 v41, v145, v107, 0
    v_dot2_f32_bf16 v43, v173, v107, 0
    v_dot2_f32_bf16 v45, v201, v107, 0
    v_dot2_f32_bf16 v47, v229, v107, 0
    v_cvt_pk_bf16_f32 v40, v40, v41
    v_cvt_pk_bf16_f32 v42, v42, v43
    v_cvt_pk_bf16_f32 v44, v44, v45
    v_cvt_pk_bf16_f32 v46, v46, v47
    v_dot2c_f32_bf16 v36, v40, v35
    v_dot2c_f32_bf16 v37, v42, v35
    v_dot2c_f32_bf16 v38, v44, v35
    v_dot2c_f32_bf16 v39, v46, v35
    global_load_dword v10, v12, s[98:99] sc1
    v_dot2_f32_bf16 v40, v146, v108, 0
    v_dot2_f32_bf16 v42, v174, v108, 0
    v_dot2_f32_bf16 v44, v202, v108, 0
    v_dot2_f32_bf16 v46, v230, v108, 0
    v_dot2_f32_bf16 v41, v146, v109, 0
    v_dot2_f32_bf16 v43, v174, v109, 0
    v_dot2_f32_bf16 v45, v202, v109, 0
    v_dot2_f32_bf16 v47, v230, v109, 0
    v_cvt_pk_bf16_f32 v40, v40, v41
    v_cvt_pk_bf16_f32 v42, v42, v43
    v_cvt_pk_bf16_f32 v44, v44, v45
    v_cvt_pk_bf16_f32 v46, v46, v47
    v_dot2c_f32_bf16 v36, v40, v35
    v_dot2c_f32_bf16 v37, v42, v35
    v_dot2c_f32_bf16 v38, v44, v35
    v_dot2c_f32_bf16 v39, v46, v35
    v_dot2_f32_bf16 v40, v147, v110, 0
    v_dot2_f32_bf16 v42, v175, v110, 0
    v_dot2_f32_bf16 v44, v203, v110, 0
    v_dot2_f32_bf16 v46, v231, v110, 0
    v_dot2_f32_bf16 v41, v147, v111, 0
    v_dot2_f32_bf16 v43, v175, v111, 0
    v_dot2_f32_bf16 v45, v203, v111, 0
    v_dot2_f32_bf16 v47, v231, v111, 0
    v_cvt_pk_bf16_f32 v40, v40, v41
    v_cvt_pk_bf16_f32 v42, v42, v43
    v_cvt_pk_bf16_f32 v44, v44, v45
    v_cvt_pk_bf16_f32 v46, v46, v47
    v_dot2c_f32_bf16 v36, v40, v35
    v_dot2c_f32_bf16 v37, v42, v35
    v_dot2c_f32_bf16 v38, v44, v35
    v_dot2c_f32_bf16 v39, v46, v35
    s_waitcnt vmcnt(10)
    v_dot2_f32_bf16 v40, v148, v112, 0
    s_waitcnt vmcnt(9)
    v_dot2_f32_bf16 v42, v176, v112, 0
    s_waitcnt vmcnt(8)
    v_dot2_f32_bf16 v44, v204, v112, 0
    s_waitcnt vmcnt(7)
    v_dot2_f32_bf16 v46, v232, v112, 0
    v_dot2_f32_bf16 v41, v148, v113, 0
    v_dot2_f32_bf16 v43, v176, v113, 0
    v_dot2_f32_bf16 v45, v204, v113, 0
    v_dot2_f32_bf16 v47, v232, v113, 0
    v_cvt_pk_bf16_f32 v40, v40, v41
    v_cvt_pk_bf16_f32 v42, v42, v43
    v_cvt_pk_bf16_f32 v44, v44, v45
    v_cvt_pk_bf16_f32 v46, v46, v47
    v_dot2c_f32_bf16 v36, v40, v35
    v_dot2c_f32_bf16 v37, v42, v35
    v_dot2c_f32_bf16 v38, v44, v35
    v_dot2c_f32_bf16 v39, v46, v35
    v_dot2_f32_bf16 v40, v149, v114, 0
    v_dot2_f32_bf16 v42, v177, v114, 0
    v_dot2_f32_bf16 v44, v205, v114, 0
    v_dot2_f32_bf16 v46, v233, v114, 0
    v_dot2_f32_bf16 v41, v149, v115, 0
    v_dot2_f32_bf16 v43, v177, v115, 0
    v_dot2_f32_bf16 v45, v205, v115, 0
    v_dot2_f32_bf16 v47, v233, v115, 0
    v_cvt_pk_bf16_f32 v40, v40, v41
    v_cvt_pk_bf16_f32 v42, v42, v43
    v_cvt_pk_bf16_f32 v44, v44, v45
    v_cvt_pk_bf16_f32 v46, v46, v47
    v_dot2c_f32_bf16 v36, v40, v35
    v_dot2c_f32_bf16 v37, v42, v35
    v_dot2c_f32_bf16 v38, v44, v35
    v_dot2c_f32_bf16 v39, v46, v35
    v_dot2_f32_bf16 v40, v150, v116, 0
    v_dot2_f32_bf16 v42, v178, v116, 0
    v_dot2_f32_bf16 v44, v206, v116, 0
    v_dot2_f32_bf16 v46, v234, v116, 0
    v_dot2_f32_bf16 v41, v150, v117, 0
    v_dot2_f32_bf16 v43, v178, v117, 0
    v_dot2_f32_bf16 v45, v206, v117, 0
    v_dot2_f32_bf16 v47, v234, v117, 0
    v_cvt_pk_bf16_f32 v40, v40, v41
    v_cvt_pk_bf16_f32 v42, v42, v43
    v_cvt_pk_bf16_f32 v44, v44, v45
    v_cvt_pk_bf16_f32 v46, v46, v47
    v_dot2c_f32_bf16 v36, v40, v35
    v_dot2c_f32_bf16 v37, v42, v35
    v_dot2c_f32_bf16 v38, v44, v35
    v_dot2c_f32_bf16 v39, v46, v35
    v_dot2_f32_bf16 v40, v151, v118, 0
    v_dot2_f32_bf16 v42, v179, v118, 0
    v_dot2_f32_bf16 v44, v207, v118, 0
    v_dot2_f32_bf16 v46, v235, v118, 0
    v_dot2_f32_bf16 v41, v151, v119, 0
    v_dot2_f32_bf16 v43, v179, v119, 0
    v_dot2_f32_bf16 v45, v207, v119, 0
    v_dot2_f32_bf16 v47, v235, v119, 0
    v_cvt_pk_bf16_f32 v40, v40, v41
    v_cvt_pk_bf16_f32 v42, v42, v43
    v_cvt_pk_bf16_f32 v44, v44, v45
    v_cvt_pk_bf16_f32 v46, v46, v47
    v_dot2c_f32_bf16 v36, v40, v35
    v_dot2c_f32_bf16 v37, v42, v35
    v_dot2c_f32_bf16 v38, v44, v35
    v_dot2c_f32_bf16 v39, v46, v35
    s_waitcnt vmcnt(6)
    v_dot2_f32_bf16 v40, v152, v120, 0
    s_waitcnt vmcnt(5)
    v_dot2_f32_bf16 v42, v180, v120, 0
    s_waitcnt vmcnt(4)
    v_dot2_f32_bf16 v44, v208, v120, 0
    s_waitcnt vmcnt(3)
    v_dot2_f32_bf16 v46, v236, v120, 0
    v_dot2_f32_bf16 v41, v152, v121, 0
    v_dot2_f32_bf16 v43, v180, v121, 0
    v_dot2_f32_bf16 v45, v208, v121, 0
    v_dot2_f32_bf16 v47, v236, v121, 0
    v_cvt_pk_bf16_f32 v40, v40, v41
    v_cvt_pk_bf16_f32 v42, v42, v43
    v_cvt_pk_bf16_f32 v44, v44, v45
    v_cvt_pk_bf16_f32 v46, v46, v47
    v_dot2c_f32_bf16 v36, v40, v35
    v_dot2c_f32_bf16 v37, v42, v35
    v_dot2c_f32_bf16 v38, v44, v35
    v_dot2c_f32_bf16 v39, v46, v35
    v_dot2_f32_bf16 v40, v153, v122, 0
    v_dot2_f32_bf16 v42, v181, v122, 0
    v_dot2_f32_bf16 v44, v209, v122, 0
    v_dot2_f32_bf16 v46, v237, v122, 0
    v_dot2_f32_bf16 v41, v153, v123, 0
    v_dot2_f32_bf16 v43, v181, v123, 0
    v_dot2_f32_bf16 v45, v209, v123, 0
    v_dot2_f32_bf16 v47, v237, v123, 0
    v_cvt_pk_bf16_f32 v40, v40, v41
    v_cvt_pk_bf16_f32 v42, v42, v43
    v_cvt_pk_bf16_f32 v44, v44, v45
    v_cvt_pk_bf16_f32 v46, v46, v47
    v_dot2c_f32_bf16 v36, v40, v35
    v_dot2c_f32_bf16 v37, v42, v35
    v_dot2c_f32_bf16 v38, v44, v35
    v_dot2c_f32_bf16 v39, v46, v35
    v_dot2_f32_bf16 v40, v154, v124, 0
    v_dot2_f32_bf16 v42, v182, v124, 0
    v_dot2_f32_bf16 v44, v210, v124, 0
    v_dot2_f32_bf16 v46, v238, v124, 0
    v_dot2_f32_bf16 v41, v154, v125, 0
    v_dot2_f32_bf16 v43, v182, v125, 0
    v_dot2_f32_bf16 v45, v210, v125, 0
    v_dot2_f32_bf16 v47, v238, v125, 0
    v_cvt_pk_bf16_f32 v40, v40, v41
    v_cvt_pk_bf16_f32 v42, v42, v43
    v_cvt_pk_bf16_f32 v44, v44, v45
    v_cvt_pk_bf16_f32 v46, v46, v47
    v_dot2c_f32_bf16 v36, v40, v35
    v_dot2c_f32_bf16 v37, v42, v35
    v_dot2c_f32_bf16 v38, v44, v35
    v_dot2c_f32_bf16 v39, v46, v35
    v_dot2_f32_bf16 v40, v155, v126, 0
    v_dot2_f32_bf16 v42, v183, v126, 0
    v_dot2_f32_bf16 v44, v211, v126, 0
    v_dot2_f32_bf16 v46, v239, v126, 0
    v_dot2_f32_bf16 v41, v155, v127, 0
    v_dot2_f32_bf16 v43, v183, v127, 0
    v_dot2_f32_bf16 v45, v211, v127, 0
    v_dot2_f32_bf16 v47, v239, v127, 0
    v_cvt_pk_bf16_f32 v40, v40, v41
    v_cvt_pk_bf16_f32 v42, v42, v43
    v_cvt_pk_bf16_f32 v44, v44, v45
    v_cvt_pk_bf16_f32 v46, v46, v47
    v_dot2c_f32_bf16 v36, v40, v35
    v_dot2c_f32_bf16 v37, v42, v35
    v_dot2c_f32_bf16 v38, v44, v35
    v_dot2c_f32_bf16 v39, v46, v35
    s_nop 2
    v_add_f32_dpp v36, v36, v36 quad_perm:[1,0,3,2] row_mask:0xf bank_mask:0xf
    v_add_f32_dpp v37, v37, v37 quad_perm:[1,0,3,2] row_mask:0xf bank_mask:0xf
    v_add_f32_dpp v38, v38, v38 quad_perm:[1,0,3,2] row_mask:0xf bank_mask:0xf
    v_add_f32_dpp v39, v39, v39 quad_perm:[1,0,3,2] row_mask:0xf bank_mask:0xf
    v_add_f32_dpp v36, v36, v36 quad_perm:[2,3,0,1] row_mask:0xf bank_mask:0xf
    v_add_f32_dpp v37, v37, v37 quad_perm:[2,3,0,1] row_mask:0xf bank_mask:0xf
    v_add_f32_dpp v38, v38, v38 quad_perm:[2,3,0,1] row_mask:0xf bank_mask:0xf
    v_add_f32_dpp v39, v39, v39 quad_perm:[2,3,0,1] row_mask:0xf bank_mask:0xf
    v_add_f32_dpp v36, v36, v36 row_half_mirror row_mask:0xf bank_mask:0xf
    v_add_f32_dpp v37, v37, v37 row_half_mirror row_mask:0xf bank_mask:0xf
    v_add_f32_dpp v38, v38, v38 row_half_mirror row_mask:0xf bank_mask:0xf
    v_add_f32_dpp v39, v39, v39 row_half_mirror row_mask:0xf bank_mask:0xf
    v_lshlrev_b32 v33, 1, v32
    ds_bpermute_b32 v36, v33, v36
    ds_bpermute_b32 v37, v33, v37
    ds_bpermute_b32 v38, v33, v38
    ds_bpermute_b32 v39, v33, v39
    s_waitcnt lgkmcnt(3)
    v_cvt_pk_bf16_f32 v36, v36, v36
    s_waitcnt lgkmcnt(2)
    v_cvt_pk_bf16_f32 v37, v37, v37
    s_waitcnt lgkmcnt(1)
    v_cvt_pk_bf16_f32 v38, v38, v38
    s_waitcnt lgkmcnt(0)
    v_cvt_pk_bf16_f32 v39, v39, v39
    v_lshlrev_b32 v36, 16, v36
    v_lshlrev_b32 v37, 16, v37
    v_lshlrev_b32 v38, 16, v38
    v_lshlrev_b32 v39, 16, v39
    v_mul_f32 v36, 0xbfb8aa3b, v36
    v_mul_f32 v37, 0xbfb8aa3b, v37
    v_mul_f32 v38, 0xbfb8aa3b, v38
    v_mul_f32 v39, 0xbfb8aa3b, v39
    v_exp_f32 v36, v36
    v_exp_f32 v37, v37
    v_exp_f32 v38, v38
    v_exp_f32 v39, v39
    v_add_f32 v36, 1.0, v36
    v_add_f32 v37, 1.0, v37
    v_add_f32 v38, 1.0, v38
    v_add_f32 v39, 1.0, v39
    v_rcp_f32 v36, v36
    v_rcp_f32 v37, v37
    v_rcp_f32 v38, v38
    v_rcp_f32 v39, v39
    v_cvt_pk_bf16_f32 v36, v36, v36
    v_cvt_pk_bf16_f32 v37, v37, v37
    v_cvt_pk_bf16_f32 v38, v38, v38
    v_cvt_pk_bf16_f32 v39, v39, v39
    v_lshlrev_b32 v36, 16, v36
    v_lshlrev_b32 v37, 16, v37
    v_lshlrev_b32 v38, 16, v38
    v_lshlrev_b32 v39, 16, v39
    v_cmp_gt_u32 vcc, 8, v16
    s_nop 1
    v_cndmask_b32 v33, v3, v32, vcc
    s_waitcnt vmcnt(0)
    v_cmp_eq_u32 vcc, 0, v10
    s_mov_b32 s51, 0
    s_cmp_eq_u64 vcc, 0
    s_cbranch_scc1 L_hgo
L_hg:
    global_load_dword v10, v12, s[98:99] sc1
    s_add_u32 s51, s51, 1
    s_waitcnt vmcnt(0)
    v_cmp_eq_u32 vcc, 0, v10
    s_cmp_ge_u32 s51, 524288
    s_cbranch_scc1 L_hgo
    s_cmp_eq_u64 vcc, 0
    s_cbranch_scc0 L_hg
L_hgo:
    s_lshl_b32 s50, s50, 7
    s_add_u32 s50, s50, 16834560
    buffer_store_dwordx4 v[36:39], v33, s[32:35], s50 offen sc1
L_hmb:
    s_barrier
    s_mul_i32 s55, s3, 57344
    s_add_u32 s55, s55, 12582912
    s_mov_b32 s54, 0
L_mb:
    buffer_store_dwordx4 v[4:7], v17, s[32:35], s55 offen sc1
    s_add_u32 s55, s55, 4096
    s_add_u32 s54, s54, 1
    s_cmp_lt_u32 s54, 14
    s_cbranch_scc1 L_mb
    s_waitcnt vmcnt(0)
    s_barrier
    s_lshl_b32 s53, s3, 10
    s_add_u32 s53, s53, 16876416
    v_cmp_gt_u32 vcc, 8, v0
    s_nop 1
    v_cndmask_b32 v17, v3, v17, vcc
    buffer_store_dwordx4 v[8:11], v17, s[32:35], s53 offen sc1
L_end:
    s_endpgm
L_slow0:
    s_mov_b32 s90, 0
L_spin0:
    buffer_load_dword v38, v255, s[8:11], 0 offen sc1
    s_add_u32 s90, s90, 1
    s_waitcnt vmcnt(0)
    s_cmp_ge_u32 s90, 524288
    s_cbranch_scc1 L_giveup0
    v_cmp_ne_u32 vcc, 0, v38
    s_nop 0
    s_cmp_eq_u32 vcc_lo, s101
    s_cbranch_scc0 L_spin0
L_giveup0:
    s_nop 1
    s_branch L_ok0
L_slow1:
    s_mov_b32 s90, 0
L_spin1:
    buffer_load_dwordx2 v[232:233], v41, s[40:43], 0 offen sc1
    buffer_load_dwordx2 v[234:235], v226, s[40:43], 0 offen sc1
    s_add_u32 s90, s90, 1
    s_waitcnt vmcnt(0)
    s_cmp_ge_u32 s90, 524288
    s_cbranch_scc1 L_giveup1
    v_max3_u32 v224, v232, v233, v234
    v_max_u32 v224, v224, v235
    v_cmp_eq_u32 vcc, -1, v224
    s_nop 0
    s_cmp_eq_u64 vcc, 0
    s_cbranch_scc0 L_spin1
L_giveup1:
    s_nop 1
    s_branch L_ok1
L_slow2:
    s_mov_b32 s90, 0
L_spin2:
    buffer_load_dword v38, v227, s[32:35], s71 offen sc1
    s_add_u32 s90, s90, 1
    s_waitcnt vmcnt(0)
    s_cmp_ge_u32 s90, 524288
    s_cbranch_scc1 L_giveup2
    v_cmp_eq_u32 vcc, -1, v38
    s_nop 0
    s_cmp_eq_u64 vcc, 0
    s_cbranch_scc0 L_spin2
L_giveup2:
    s_nop 1
    s_branch L_ok2
L_slow3:
    s_mov_b32 s90, 0
L_spin3:
    buffer_load_dword v38, v42, s[32:35], s81 offen offset:4 sc1
    s_add_u32 s90, s90, 1
    s_waitcnt vmcnt(0)
    s_cmp_ge_u32 s90, 524288
    s_cbranch_scc1 L_giveup3
    v_cmp_eq_u32 vcc, 1, v38
    s_nop 0
    s_cmp_eq_u32 vcc_lo, s95
    s_cbranch_scc0 L_spin3
L_giveup3:
    s_nop 1
    s_branch L_ok3
L_slow4:
    s_mov_b32 s90, 0
L_spin4:
    buffer_load_dword v38, v43, s[32:35], s82 offen offset:4 sc1
    s_add_u32 s90, s90, 1
    s_waitcnt vmcnt(0)
    s_cmp_ge_u32 s90, 524288
    s_cbranch_scc1 L_giveup4
    v_cmp_eq_u32 vcc, 1, v38
    s_nop 0
    s_cmp_eq_u32 vcc_lo, s100
    s_cbranch_scc0 L_spin4
L_giveup4:
    s_nop 1
    s_branch L_ok4
L_slow5:
    s_mov_b32 s90, 0
L_spin5:
    buffer_load_dword v38, v42, s[32:35], s81 offen offset:4 sc1
    s_add_u32 s90, s90, 1
    s_waitcnt vmcnt(0)
    s_cmp_ge_u32 s90, 524288
    s_cbranch_scc1 L_giveup5
    v_cmp_eq_u32 vcc, 1, v38
    s_nop 0
    s_cmp_eq_u32 vcc_lo, s95
    s_cbranch_scc0 L_spin5
L_giveup5:
    s_nop 1
    s_branch L_ok5
.p2align 12
L_body:
L_pg0:
    s_cbranch_execz L_back
    s_waitcnt vmcnt(10) lgkmcnt(0)
    s_barrier
    ds_read_b128 v[208:211], v184 offset:49152
    ds_read_b128 a[0:3], v182 offset:0
    ds_read_b128 v[212:215], v184 offset:53248
    ds_read_b128 a[4:7], v182 offset:512
    ds_read_b128 a[8:11], v182 offset:1024
    ds_read_b128 a[12:15], v182 offset:1536
    s_waitcnt lgkmcnt(4)
    v_mfma_f32_16x16x32_bf16 v[64:67], a[0:3], v[208:211], 0
    ds_read_b128 v[216:219], v185 offset:49152
    ds_read_b128 a[16:19], v183 offset:0
    s_add_u32 m0, s52, 32768
    s_nop 0
    buffer_load_dwordx4 v176, s[4:7], s58 offen lds
    s_waitcnt lgkmcnt(5)
    v_mfma_f32_16x16x32_bf16 v[80:83], a[0:3], v[212:215], 0
    ds_read_b128 v[220:223], v185 offset:53248
    ds_read_b128 a[20:23], v183 offset:512
    buffer_load_dwordx4 v177, s[4:7], s58 offen offset:1024 lds
    buffer_load_dwordx4 v178, s[4:7], s58 offen offset:2048 lds
    s_waitcnt lgkmcnt(6)
    v_mfma_f32_16x16x32_bf16 v[68:71], a[4:7], v[208:211], 0
    ds_read_b128 a[24:27], v183 offset:1024
    ds_read_b128 a[28:31], v183 offset:1536
    buffer_load_dwordx4 v179, s[4:7], s58 offen offset:3072 lds
    s_add_u32 m0, s50, 131072
    v_mfma_f32_16x16x32_bf16 v[84:87], a[4:7], v[212:215], 0
    buffer_load_dwordx4 v180, s[8:11], s58 offen lds
    s_waitcnt lgkmcnt(7)
    v_mfma_f32_16x16x32_bf16 v[72:75], a[8:11], v[208:211], 0
    s_add_u32 m0, s50, 135168
    s_nop 0
    buffer_load_dwordx4 v180, s[12:15], s58 offen lds
    v_mfma_f32_16x16x32_bf16 v[88:91], a[8:11], v[212:215], 0
    s_add_u32 m0, s52, 49152
    s_nop 0
    buffer_load_dwordx4 v176, s[4:7], s59 offen lds
    s_waitcnt lgkmcnt(6)
    v_mfma_f32_16x16x32_bf16 v[76:79], a[12:15], v[208:211], 0
    buffer_load_dwordx4 v177, s[4:7], s59 offen offset:1024 lds
    buffer_load_dwordx4 v178, s[4:7], s59 offen offset:2048 lds
    v_mfma_f32_16x16x32_bf16 v[92:95], a[12:15], v[212:215], 0
    buffer_load_dwordx4 v179, s[4:7], s59 offen offset:3072 lds
    s_waitcnt vmcnt(10)
    s_barrier
    s_waitcnt lgkmcnt(4)
    v_mfma_f32_16x16x32_bf16 v[64:67], a[16:19], v[216:219], v[64:67]
    ds_read_b128 v[208:211], v184 offset:40960
    ds_read_b128 a[32:35], v182 offset:16384
    s_add_u32 m0, s50, 122880
    v_lshlrev_b32 v190, 16, v190
    v_lshlrev_b32 v191, 16, v191
    s_waitcnt lgkmcnt(5)
    v_mfma_f32_16x16x32_bf16 v[80:83], a[16:19], v[220:223], v[80:83]
    ds_read_b128 v[212:215], v184 offset:45056
    ds_read_b128 a[36:39], v182 offset:16896
    buffer_load_dwordx4 v180, s[8:11], s59 offen lds
    s_waitcnt lgkmcnt(6)
    v_mfma_f32_16x16x32_bf16 v[68:71], a[20:23], v[216:219], v[68:71]
    ds_read_b128 a[40:43], v182 offset:17408
    ds_read_b128 a[44:47], v182 offset:17920
    s_add_u32 m0, s50, 126976
    v_lshlrev_b32 v192, 16, v192
    v_mul_f32 v192, 0x3fb8aa3b, v192
    v_mfma_f32_16x16x32_bf16 v[84:87], a[20:23], v[220:223], v[84:87]
    buffer_load_dwordx4 v180, s[12:15], s59 offen lds
    s_waitcnt lgkmcnt(7)
    v_mfma_f32_16x16x32_bf16 v[72:75], a[24:27], v[216:219], v[72:75]
    s_add_u32 m0, s52, 65536
    v_exp_f32 v192, v192
    v_mul_f32 v236, v190, v190
    v_cvt_pk_bf16_f32 v192, v192, v192
    v_mfma_f32_16x16x32_bf16 v[88:91], a[24:27], v[220:223], v[88:91]
    v_lshlrev_b32 v192, 16, v192
    v_mul_f32 v232, v192, v190
    v_mul_f32 v233, v192, v191
    v_mul_f32 v232, 0x3fb8aa3b, v232
    s_waitcnt lgkmcnt(6)
    v_mfma_f32_16x16x32_bf16 v[76:79], a[28:31], v[216:219], v[76:79]
    buffer_load_dwordx4 v176, s[4:7], s60 offen lds
    v_mfma_f32_16x16x32_bf16 v[92:95], a[28:31], v[220:223], v[92:95]
    buffer_load_dwordx4 v177, s[4:7], s60 offen offset:1024 lds
    s_waitcnt lgkmcnt(4)
    v_mfma_f32_16x16x32_bf16 v[64:67], a[32:35], v[208:211], v[64:67]
    ds_read_b128 v[216:219], v185 offset:40960
    ds_read_b128 a[48:51], v183 offset:16384
    buffer_load_dwordx4 v178, s[4:7], s60 offen offset:2048 lds
    s_waitcnt lgkmcnt(5)
    v_mfma_f32_16x16x32_bf16 v[80:83], a[32:35], v[212:215], v[80:83]
    ds_read_b128 v[220:223], v185 offset:45056
    ds_read_b128 a[52:55], v183 offset:16896
    buffer_load_dwordx4 v179, s[4:7], s60 offen offset:3072 lds
    s_waitcnt lgkmcnt(6)
    v_mfma_f32_16x16x32_bf16 v[68:71], a[36:39], v[208:211], v[68:71]
    ds_read_b128 a[56:59], v183 offset:17408
    ds_read_b128 a[60:63], v183 offset:17920
    v_exp_f32 v232, v232
    v_mul_f32 v233, 0.15915494, v233
    v_mfma_f32_16x16x32_bf16 v[84:87], a[36:39], v[212:215], v[84:87]
    s_add_u32 m0, s50, 114688
    v_rndne_f32 v234, v233
    v_sub_f32 v233, v233, v234
    v_cos_f32 v234, v233
    s_waitcnt lgkmcnt(7)
    v_mfma_f32_16x16x32_bf16 v[72:75], a[40:43], v[208:211], v[72:75]
    buffer_load_dwordx4 v180, s[8:11], s60 offen lds
    v_mfma_f32_16x16x32_bf16 v[88:91], a[40:43], v[212:215], v[88:91]
    s_add_u32 m0, s50, 118784
    v_sin_f32 v235, v233
    v_fmac_f32 v236, v191, v191
    v_mul_f32 v9, v232, v234
    s_waitcnt lgkmcnt(6)
    v_mfma_f32_16x16x32_bf16 v[76:79], a[44:47], v[208:211], v[76:79]
    buffer_load_dwordx4 v180, s[12:15], s60 offen lds
    v_mfma_f32_16x16x32_bf16 v[92:95], a[44:47], v[212:215], v[92:95]
    v_mul_f32 v10, v232, v235
    v_rcp_f32 v236, v236
    v_sub_f32 v11, 0, v10
    s_mov_b64 exec, 0
    s_branch L_pg4
L_back2:
    s_mov_b64 exec, -1
    s_waitcnt vmcnt(12)
    s_barrier
    s_waitcnt lgkmcnt(4)
    v_mfma_f32_16x16x32_bf16 v[64:67], a[48:51], v[216:219], v[64:67]
    ds_read_b128 v[208:211], v184 offset:32768
    ds_read_b128 a[64:67], v182 offset:32768
    s_add_u32 m0, s52, 0
    v_add_f32 v233, -1.0, v9
    v_add_f32 v236, v236, v236
    s_waitcnt lgkmcnt(5)
    v_mfma_f32_16x16x32_bf16 v[80:83], a[48:51], v[220:223], v[80:83]
    ds_read_b128 v[212:215], v184 offset:36864
    ds_read_b128 a[68:71], v182 offset:33280
    buffer_load_dwordx4 v176, s[4:7], s61 offen lds
    s_waitcnt lgkmcnt(6)
    v_mfma_f32_16x16x32_bf16 v[68:71], a[52:55], v[216:219], v[68:71]
    ds_read_b128 a[72:75], v182 offset:33792
    ds_read_b128 a[76:79], v182 offset:34304
    v_mul_f32 v234, v233, v190
    v_fmac_f32 v234, v10, v191
    v_mul_f32 v235, v10, v190
    v_mfma_f32_16x16x32_bf16 v[84:87], a[52:55], v[220:223], v[84:87]
    buffer_load_dwordx4 v177, s[4:7], s61 offen offset:1024 lds
    s_waitcnt lgkmcnt(7)
    v_mfma_f32_16x16x32_bf16 v[72:75], a[56:59], v[216:219], v[72:75]
    v_fma_f32 v235, -v233, v191, v235
    v_mul_f32 v12, v234, v236
    v_mul_f32 v13, v235, v236
    v_sub_f32 v16, 0, v13
    v_mul_f32 v160, v9, v9
    v_mfma_f32_16x16x32_bf16 v[88:91], a[56:59], v[220:223], v[88:91]
    buffer_load_dwordx4 v178, s[4:7], s61 offen offset:2048 lds
    s_waitcnt lgkmcnt(6)
    v_mfma_f32_16x16x32_bf16 v[76:79], a[60:63], v[216:219], v[76:79]
    v_mul_f32 v161, v9, v10
    v_fma_f32 v160, -v10, v10, v160
    v_add_f32 v161, v161, v161
    v_mul_f32 v234, v160, v160
    v_mul_f32 v235, v160, v161
    v_mfma_f32_16x16x32_bf16 v[92:95], a[60:63], v[220:223], v[92:95]
    buffer_load_dwordx4 v179, s[4:7], s61 offen offset:3072 lds
    s_waitcnt lgkmcnt(4)
    v_mfma_f32_16x16x32_bf16 v[64:67], a[64:67], v[208:211], v[64:67]
    ds_read_b128 v[216:219], v185 offset:32768
    ds_read_b128 a[80:83], v183 offset:32768
    s_add_u32 m0, s50, 147456
    v_fma_f32 v234, -v161, v161, v234
    s_waitcnt lgkmcnt(5)
    v_mfma_f32_16x16x32_bf16 v[80:83], a[64:67], v[212:215], v[80:83]
    ds_read_b128 v[220:223], v185 offset:36864
    ds_read_b128 a[84:87], v183 offset:33280
    v_add_f32 v235, v235, v235
    v_mul_f32 v232, v234, v234
    s_waitcnt lgkmcnt(6)
    v_mfma_f32_16x16x32_bf16 v[68:71], a[68:71], v[208:211], v[68:71]
    ds_read_b128 a[88:91], v183 offset:33792
    ds_read_b128 a[92:95], v183 offset:34304
    buffer_load_dwordx4 v180, s[8:11], s61 offen lds
    v_mfma_f32_16x16x32_bf16 v[84:87], a[68:71], v[212:215], v[84:87]
    v_mul_f32 v233, v234, v235
    v_fma_f32 v232, -v235, v235, v232
    v_add_f32 v233, v233, v233
    v_and_b32 v238, 1, v253
    s_waitcnt lgkmcnt(7)
    v_mfma_f32_16x16x32_bf16 v[72:75], a[72:75], v[208:211], v[72:75]
    s_add_u32 m0, s50, 151552
    v_cmp_eq_u32 s[98:99], 1, v238
    v_mul_f32 v14, v232, v232
    v_mul_f32 v15, v232, v233
    v_mfma_f32_16x16x32_bf16 v[88:91], a[72:75], v[212:215], v[88:91]
    v_fma_f32 v14, -v233, v233, v14
    v_add_f32 v15, v15, v15
    v_cndmask_b32 v21, 1.0, v14, s[98:99]
    v_cndmask_b32 v22, 0, v15, s[98:99]
    s_waitcnt lgkmcnt(6)
    v_mfma_f32_16x16x32_bf16 v[76:79], a[76:79], v[208:211], v[76:79]
    buffer_load_dwordx4 v180, s[12:15], s61 offen lds
    v_mfma_f32_16x16x32_bf16 v[92:95], a[76:79], v[212:215], v[92:95]
    v_and_b32 v238, 2, v253
    v_cmp_eq_u32 s[98:99], 2, v238
    v_mul_f32 v232, v14, v14
    s_waitcnt vmcnt(12)
    s_barrier
    s_waitcnt lgkmcnt(4)
    v_mfma_f32_16x16x32_bf16 v[64:67], a[80:83], v[216:219], v[64:67]
    ds_read_b128 v[208:211], v184 offset:24576
    ds_read_b128 a[96:99], v182 offset:49152
    s_add_u32 m0, s52, 16384
    v_mul_f32 v233, v14, v15
    s_waitcnt lgkmcnt(5)
    v_mfma_f32_16x16x32_bf16 v[80:83], a[80:83], v[220:223], v[80:83]
    ds_read_b128 v[212:215], v184 offset:28672
    ds_read_b128 a[100:103], v182 offset:49664
    buffer_load_dwordx4 v176, s[4:7], s62 offen lds
    s_waitcnt lgkmcnt(6)
    v_mfma_f32_16x16x32_bf16 v[68:71], a[84:87], v[216:219], v[68:71]
    ds_read_b128 a[104:107], v182 offset:50176
    ds_read_b128 a[108:111], v182 offset:50688
    v_fma_f32 v232, -v15, v15, v232
    v_add_f32 v233, v233, v233
    v_mfma_f32_16x16x32_bf16 v[84:87], a[84:87], v[220:223], v[84:87]
    buffer_load_dwordx4 v177, s[4:7], s62 offen offset:1024 lds
    s_waitcnt lgkmcnt(7)
    v_mfma_f32_16x16x32_bf16 v[72:75], a[88:91], v[216:219], v[72:75]
    v_mul_f32 v236, v21, v232
    v_mul_f32 v237, v21, v233
    v_fma_f32 v236, -v22, v233, v236
    v_fmac_f32 v237, v22, v232
    v_mfma_f32_16x16x32_bf16 v[88:91], a[88:91], v[220:223], v[88:91]
    buffer_load_dwordx4 v178, s[4:7], s62 offen offset:2048 lds
    s_waitcnt lgkmcnt(6)
    v_mfma_f32_16x16x32_bf16 v[76:79], a[92:95], v[216:219], v[76:79]
    v_cndmask_b32 v21, v21, v236, s[98:99]
    v_cndmask_b32 v22, v22, v237, s[98:99]
    v_cmp_lt_u32 s[98:99], 3, v253
    v_mul_f32 v234, v232, v232
    v_mfma_f32_16x16x32_bf16 v[92:95], a[92:95], v[220:223], v[92:95]
    buffer_load_dwordx4 v179, s[4:7], s62 offen offset:3072 lds
    s_waitcnt lgkmcnt(4)
    v_mfma_f32_16x16x32_bf16 v[64:67], a[96:99], v[208:211], v[64:67]
    ds_read_b128 v[216:219], v185 offset:24576
    ds_read_b128 a[112:115], v183 offset:49152
    s_add_u32 m0, s50, 139264
    v_mul_f32 v235, v232, v233
    s_waitcnt lgkmcnt(5)
    v_mfma_f32_16x16x32_bf16 v[80:83], a[96:99], v[212:215], v[80:83]
    ds_read_b128 v[220:223], v185 offset:28672
    ds_read_b128 a[116:119], v183 offset:49664
    v_fma_f32 v234, -v233, v233, v234
    v_add_f32 v235, v235, v235
    s_waitcnt lgkmcnt(6)
    v_mfma_f32_16x16x32_bf16 v[68:71], a[100:103], v[208:211], v[68:71]
    ds_read_b128 a[120:123], v183 offset:50176
    ds_read_b128 a[124:127], v183 offset:50688
    buffer_load_dwordx4 v180, s[8:11], s62 offen lds
    v_mfma_f32_16x16x32_bf16 v[84:87], a[100:103], v[212:215], v[84:87]
    v_mul_f32 v236, v21, v234
    v_mul_f32 v237, v21, v235
    v_fma_f32 v236, -v22, v235, v236
    v_fmac_f32 v237, v22, v234
    s_waitcnt lgkmcnt(7)
    v_mfma_f32_16x16x32_bf16 v[72:75], a[104:107], v[208:211], v[72:75]
    s_add_u32 m0, s50, 143360
    v_cndmask_b32 v21, v21, v236, s[98:99]
    v_cndmask_b32 v22, v22, v237, s[98:99]
    v_mul_f32 v18, v234, v234
    v_mfma_f32_16x16x32_bf16 v[88:91], a[104:107], v[212:215], v[88:91]
    v_mul_f32 v19, v234, v235
    v_fma_f32 v18, -v235, v235, v18
    v_add_f32 v19, v19, v19
    v_mul_f32 v17, v18, v18
    s_waitcnt lgkmcnt(6)
    v_mfma_f32_16x16x32_bf16 v[76:79], a[108:111], v[208:211], v[76:79]
    buffer_load_dwordx4 v180, s[12:15], s62 offen lds
    v_mfma_f32_16x16x32_bf16 v[92:95], a[108:111], v[212:215], v[92:95]
    v_mul_f32 v20, v18, v19
    v_fma_f32 v17, -v19, v19, v17
    v_add_f32 v20, v20, v20
    s_waitcnt vmcnt(12)
    s_barrier
    s_waitcnt lgkmcnt(4)
    v_mfma_f32_16x16x32_bf16 v[64:67], a[112:115], v[216:219], v[64:67]
    ds_read_b128 v[208:211], v184 offset:16384
    v_add_u32 v182, 0x10000, v182
    ds_read_b128 a[128:131], v182 offset:0
    s_add_u32 m0, s51, 32768
    s_waitcnt lgkmcnt(5)
    v_mfma_f32_16x16x32_bf16 v[80:83], a[112:115], v[220:223], v[80:83]
    ds_read_b128 v[212:215], v184 offset:20480
    ds_read_b128 a[132:135], v182 offset:512
    s_waitcnt lgkmcnt(6)
    v_mfma_f32_16x16x32_bf16 v[68:71], a[116:119], v[216:219], v[68:71]
    ds_read_b128 a[136:139], v182 offset:1024
    ds_read_b128 a[140:143], v182 offset:1536
    buffer_load_dwordx4 v5, s[16:19], s63 offen lds
    v_mfma_f32_16x16x32_bf16 v[84:87], a[116:119], v[220:223], v[84:87]
    s_waitcnt lgkmcnt(7)
    v_mfma_f32_16x16x32_bf16 v[72:75], a[120:123], v[216:219], v[72:75]
    v_mfma_f32_16x16x32_bf16 v[88:91], a[120:123], v[220:223], v[88:91]
    buffer_load_dwordx4 v6, s[16:19], s63 offen offset:1024 lds
    s_waitcnt lgkmcnt(6)
    v_mfma_f32_16x16x32_bf16 v[76:79], a[124:127], v[216:219], v[76:79]
    v_mfma_f32_16x16x32_bf16 v[92:95], a[124:127], v[220:223], v[92:95]
    s_waitcnt lgkmcnt(4)
    v_mfma_f32_16x16x32_bf16 v[64:67], a[128:131], v[208:211], v[64:67]
    ds_read_b128 v[216:219], v185 offset:16384
    v_add_u32 v183, 0x10000, v183
    ds_read_b128 a[144:147], v183 offset:0
    s_add_u32 m0, s51, 40960
    s_waitcnt lgkmcnt(5)
    v_mfma_f32_16x16x32_bf16 v[80:83], a[128:131], v[212:215], v[80:83]
    ds_read_b128 v[220:223], v185 offset:20480
    ds_read_b128 a[148:151], v183 offset:512
    s_waitcnt lgkmcnt(6)
    v_mfma_f32_16x16x32_bf16 v[68:71], a[132:135], v[208:211], v[68:71]
    ds_read_b128 a[152:155], v183 offset:1024
    ds_read_b128 a[156:159], v183 offset:1536
    buffer_load_dwordx4 v5, s[20:23], s63 offen lds
    v_mfma_f32_16x16x32_bf16 v[84:87], a[132:135], v[212:215], v[84:87]
    s_waitcnt lgkmcnt(7)
    v_mfma_f32_16x16x32_bf16 v[72:75], a[136:139], v[208:211], v[72:75]
    v_mfma_f32_16x16x32_bf16 v[88:91], a[136:139], v[212:215], v[88:91]
    buffer_load_dwordx4 v6, s[20:23], s63 offen offset:1024 lds
    s_waitcnt lgkmcnt(6)
    v_mfma_f32_16x16x32_bf16 v[76:79], a[140:143], v[208:211], v[76:79]
    v_mfma_f32_16x16x32_bf16 v[92:95], a[140:143], v[212:215], v[92:95]
    s_waitcnt vmcnt(10)
    s_barrier
    s_waitcnt lgkmcnt(4)
    v_mfma_f32_16x16x32_bf16 v[64:67], a[144:147], v[216:219], v[64:67]
    ds_read_b128 v[208:211], v184 offset:49152
    v_add_u32 v182, 0xffff0000, v182
    ds_read_b128 a[160:163], v182 offset:0
    s_add_u32 m0, s51, 49152
    s_mov_b64 s[8:9], s[88:89]
    s_mov_b32 s10, 256
    s_waitcnt lgkmcnt(5)
    v_mfma_f32_16x16x32_bf16 v[80:83], a[144:147], v[220:223], v[80:83]
    ds_read_b128 v[212:215], v184 offset:53248
    ds_read_b128 a[164:167], v182 offset:512
    s_waitcnt lgkmcnt(6)
    v_mfma_f32_16x16x32_bf16 v[68:71], a[148:151], v[216:219], v[68:71]
    ds_read_b128 a[168:171], v182 offset:1024
    ds_read_b128 a[172:175], v182 offset:1536
    buffer_load_dwordx4 v5, s[16:19], s64 offen lds
    v_mfma_f32_16x16x32_bf16 v[84:87], a[148:151], v[220:223], v[84:87]
    s_waitcnt lgkmcnt(7)
    v_mfma_f32_16x16x32_bf16 v[72:75], a[152:155], v[216:219], v[72:75]
    v_mfma_f32_16x16x32_bf16 v[88:91], a[152:155], v[220:223], v[88:91]
    buffer_load_dwordx4 v6, s[16:19], s64 offen offset:1024 lds
    s_waitcnt lgkmcnt(6)
    v_mfma_f32_16x16x32_bf16 v[76:79], a[156:159], v[216:219], v[76:79]
    v_mfma_f32_16x16x32_bf16 v[92:95], a[156:159], v[220:223], v[92:95]
    s_waitcnt lgkmcnt(4)
    v_mfma_f32_16x16x32_bf16 v[64:67], a[160:163], v[208:211], v[64:67]
    ds_read_b128 v[216:219], v185 offset:49152
    v_add_u32 v183, 0xffff0000, v183
    ds_read_b128 a[176:179], v183 offset:0
    s_add_u32 m0, s51, 57344
    s_waitcnt lgkmcnt(5)
    v_mfma_f32_16x16x32_bf16 v[80:83], a[160:163], v[212:215], v[80:83]
    ds_read_b128 v[220:223], v185 offset:53248
    ds_read_b128 a[180:183], v183 offset:512
    s_waitcnt lgkmcnt(6)
    v_mfma_f32_16x16x32_bf16 v[68:71], a[164:167], v[208:211], v[68:71]
    ds_read_b128 a[184:187], v183 offset:1024
    ds_read_b128 a[188:191], v183 offset:1536
    buffer_load_dwordx4 v5, s[20:23], s64 offen lds
    v_mfma_f32_16x16x32_bf16 v[84:87], a[164:167], v[212:215], v[84:87]
    s_waitcnt lgkmcnt(7)
    v_mfma_f32_16x16x32_bf16 v[72:75], a[168:171], v[208:211], v[72:75]
    v_mfma_f32_16x16x32_bf16 v[88:91], a[168:171], v[212:215], v[88:91]
    buffer_load_dwordx4 v6, s[20:23], s64 offen offset:1024 lds
    s_waitcnt lgkmcnt(6)
    v_mfma_f32_16x16x32_bf16 v[76:79], a[172:175], v[208:211], v[76:79]
    v_mfma_f32_16x16x32_bf16 v[92:95], a[172:175], v[212:215], v[92:95]
    s_waitcnt vmcnt(8)
    s_barrier
    s_waitcnt lgkmcnt(4)
    v_mfma_f32_16x16x32_bf16 v[64:67], a[176:179], v[216:219], v[64:67]
    ds_read_b128 v[208:211], v184 offset:40960
    ds_read_b128 a[192:195], v182 offset:16384
    s_add_u32 m0, s51, 65536
    buffer_load_dword v38, v255, s[8:11], 0 offen sc1
    s_waitcnt lgkmcnt(5)
    v_mfma_f32_16x16x32_bf16 v[80:83], a[176:179], v[220:223], v[80:83]
    ds_read_b128 v[212:215], v184 offset:45056
    ds_read_b128 a[196:199], v182 offset:16896
    buffer_load_dwordx4 v5, s[16:19], s65 offen lds
    s_waitcnt lgkmcnt(6)
    v_mfma_f32_16x16x32_bf16 v[68:71], a[180:183], v[216:219], v[68:71]
    ds_read_b128 a[200:203], v182 offset:17408
    ds_read_b128 a[204:207], v182 offset:17920
    v_mfma_f32_16x16x32_bf16 v[84:87], a[180:183], v[220:223], v[84:87]
    buffer_load_dwordx4 v6, s[16:19], s65 offen offset:1024 lds
    s_waitcnt lgkmcnt(7)
    v_mfma_f32_16x16x32_bf16 v[72:75], a[184:187], v[216:219], v[72:75]
    v_mfma_f32_16x16x32_bf16 v[88:91], a[184:187], v[220:223], v[88:91]
    s_add_u32 m0, s51, 73728
    s_waitcnt lgkmcnt(6)
    v_mfma_f32_16x16x32_bf16 v[76:79], a[188:191], v[216:219], v[76:79]
    buffer_load_dwordx4 v5, s[20:23], s65 offen lds
    v_mfma_f32_16x16x32_bf16 v[92:95], a[188:191], v[220:223], v[92:95]
    s_waitcnt lgkmcnt(4)
    v_mfma_f32_16x16x32_bf16 v[64:67], a[192:195], v[208:211], v[64:67]
    ds_read_b128 v[216:219], v185 offset:40960
    ds_read_b128 a[208:211], v183 offset:16384
    buffer_load_dwordx4 v6, s[20:23], s65 offen offset:1024 lds
    s_waitcnt lgkmcnt(5)
    v_mfma_f32_16x16x32_bf16 v[80:83], a[192:195], v[212:215], v[80:83]
    ds_read_b128 v[220:223], v185 offset:45056
    ds_read_b128 a[212:215], v183 offset:16896
    s_waitcnt lgkmcnt(6)
    v_mfma_f32_16x16x32_bf16 v[68:71], a[196:199], v[208:211], v[68:71]
    ds_read_b128 a[216:219], v183 offset:17408
    ds_read_b128 a[220:223], v183 offset:17920
    s_add_u32 m0, s51, 131072
    v_mfma_f32_16x16x32_bf16 v[84:87], a[196:199], v[212:215], v[84:87]
    buffer_load_dwordx4 v30, s[28:31], s56 offen lds
    s_waitcnt lgkmcnt(7)
    v_mfma_f32_16x16x32_bf16 v[72:75], a[200:203], v[208:211], v[72:75]
    v_mfma_f32_16x16x32_bf16 v[88:91], a[200:203], v[212:215], v[88:91]
    buffer_load_dwordx4 v31, s[28:31], s56 offen offset:1024 lds
    s_waitcnt lgkmcnt(6)
    v_mfma_f32_16x16x32_bf16 v[76:79], a[204:207], v[208:211], v[76:79]
    v_mfma_f32_16x16x32_bf16 v[92:95], a[204:207], v[212:215], v[92:95]
    s_waitcnt vmcnt(11)
    s_barrier
    s_waitcnt lgkmcnt(4)
    v_mfma_f32_16x16x32_bf16 v[64:67], a[208:211], v[216:219], v[64:67]
    ds_read_b64_tr_b16 v[56:57], v3 offset:32768
    ds_read_b64_tr_b16 v[58:59], v3 offset:33280
    s_add_u32 m0, s51, 0
    s_nop 0
    buffer_load_dwordx4 v5, s[16:19], s66 offen lds
    s_waitcnt lgkmcnt(5)
    v_mfma_f32_16x16x32_bf16 v[80:83], a[208:211], v[220:223], v[80:83]
    ds_read_b64_tr_b16 v[60:61], v3 offset:40960
    s_waitcnt lgkmcnt(5)
    v_mfma_f32_16x16x32_bf16 v[68:71], a[212:215], v[216:219], v[68:71]
    ds_read_b64_tr_b16 v[62:63], v3 offset:41472
    v_mfma_f32_16x16x32_bf16 v[84:87], a[212:215], v[220:223], v[84:87]
    ds_read_b64_tr_b16 a[248:249], v4 offset:32768
    ds_read_b64_tr_b16 a[250:251], v4 offset:33280
    buffer_load_dwordx4 v6, s[16:19], s66 offen offset:1024 lds
    s_waitcnt lgkmcnt(7)
    v_mfma_f32_16x16x32_bf16 v[72:75], a[216:219], v[216:219], v[72:75]
    ds_read_b64_tr_b16 a[252:253], v4 offset:40960
    v_mfma_f32_16x16x32_bf16 v[88:91], a[216:219], v[220:223], v[88:91]
    ds_read_b64_tr_b16 a[254:255], v4 offset:41472
    s_add_u32 m0, s51, 8192
    s_waitcnt lgkmcnt(8)
    v_mfma_f32_16x16x32_bf16 v[76:79], a[220:223], v[216:219], v[76:79]
    buffer_load_dwordx4 v5, s[20:23], s66 offen lds
    v_mfma_f32_16x16x32_bf16 v[92:95], a[220:223], v[220:223], v[92:95]
    v_pk_fma_f32 v[166:167], v[160:161], v[64:65], v[66:67] op_sel_hi:[0,1,1]
    v_pk_fma_f32 v[168:169], v[160:161], v[80:81], v[82:83] op_sel_hi:[0,1,1]
    v_pk_fma_f32 v[166:167], v[160:161], v[80:81], v[166:167] op_sel:[1,0,0] neg_lo:[1,0,0] neg_hi:[1,0,0]
    v_pk_fma_f32 v[168:169], v[160:161], v[64:65], v[168:169] op_sel:[1,0,0]
    v_pk_fma_f32 v[162:163], v[160:161], v[166:167], v[68:69] op_sel_hi:[0,1,1]
    v_pk_fma_f32 v[164:165], v[160:161], v[168:169], v[84:85] op_sel_hi:[0,1,1]
    v_pk_fma_f32 v[162:163], v[160:161], v[168:169], v[162:163] op_sel:[1,0,0] neg_lo:[1,0,0] neg_hi:[1,0,0]
    v_pk_fma_f32 v[164:165], v[160:161], v[166:167], v[164:165] op_sel:[1,0,0]
    v_pk_fma_f32 v[166:167], v[160:161], v[162:163], v[70:71] op_sel_hi:[0,1,1]
    v_pk_fma_f32 v[168:169], v[160:161], v[164:165], v[86:87] op_sel_hi:[0,1,1]
    v_pk_fma_f32 v[166:167], v[160:161], v[164:165], v[166:167] op_sel:[1,0,0] neg_lo:[1,0,0] neg_hi:[1,0,0]
    v_pk_fma_f32 v[168:169], v[160:161], v[162:163], v[168:169] op_sel:[1,0,0]
    v_pk_fma_f32 v[162:163], v[160:161], v[166:167], v[72:73] op_sel_hi:[0,1,1]
    v_pk_fma_f32 v[164:165], v[160:161], v[168:169], v[88:89] op_sel_hi:[0,1,1]
    v_pk_fma_f32 v[162:163], v[160:161], v[168:169], v[162:163] op_sel:[1,0,0] neg_lo:[1,0,0] neg_hi:[1,0,0]
    v_pk_fma_f32 v[164:165], v[160:161], v[166:167], v[164:165] op_sel:[1,0,0]
    v_pk_fma_f32 v[166:167], v[160:161], v[162:163], v[74:75] op_sel_hi:[0,1,1]
    v_pk_fma_f32 v[168:169], v[160:161], v[164:165], v[90:91] op_sel_hi:[0,1,1]
    v_pk_fma_f32 v[166:167], v[160:161], v[164:165], v[166:167] op_sel:[1,0,0] neg_lo:[1,0,0] neg_hi:[1,0,0]
    v_pk_fma_f32 v[168:169], v[160:161], v[162:163], v[168:169] op_sel:[1,0,0]
    v_pk_fma_f32 v[162:163], v[160:161], v[166:167], v[76:77] op_sel_hi:[0,1,1]
    v_pk_fma_f32 v[164:165], v[160:161], v[168:169], v[92:93] op_sel_hi:[0,1,1]
    v_pk_fma_f32 v[162:163], v[160:161], v[168:169], v[162:163] op_sel:[1,0,0] neg_lo:[1,0,0] neg_hi:[1,0,0]
    v_pk_fma_f32 v[164:165], v[160:161], v[166:167], v[164:165] op_sel:[1,0,0]
    v_pk_fma_f32 v[166:167], v[160:161], v[162:163], v[78:79] op_sel_hi:[0,1,1]
    v_pk_fma_f32 v[168:169], v[160:161], v[164:165], v[94:95] op_sel_hi:[0,1,1]
    v_pk_fma_f32 v[166:167], v[160:161], v[164:165], v[166:167] op_sel:[1,0,0] neg_lo:[1,0,0] neg_hi:[1,0,0]
    v_pk_fma_f32 v[168:169], v[160:161], v[162:163], v[168:169] op_sel:[1,0,0]
    v_fma_f32 v228, v9, v166, v167
    v_fma_f32 v229, v9, v168, v169
    v_fma_f32 v228, -v10, v168, v228
    v_fmac_f32 v229, v10, v166
    s_waitcnt lgkmcnt(4)
    v_mfma_f32_16x16x32_bf16 v[96:99], v[56:59], a[0:3], 0
    ds_read_b64_tr_b16 v[48:49], v3 offset:36864
    ds_write_b64 v23, v[228:229] offset:1792
    v_mfma_f32_16x16x32_bf16 v[112:115], v[56:59], a[4:7], 0
    ds_read_b64_tr_b16 v[50:51], v3 offset:37376
    v_mfma_f32_16x16x32_bf16 v[128:131], v[56:59], a[8:11], 0
    ds_read_b64_tr_b16 v[52:53], v3 offset:45056
    buffer_load_dwordx4 v6, s[20:23], s66 offen offset:1024 lds
    v_mfma_f32_16x16x32_bf16 v[144:147], v[56:59], a[12:15], 0
    ds_read_b64_tr_b16 v[54:55], v3 offset:45568
    v_mfma_f32_16x16x32_bf16 v[104:107], v[60:63], a[0:3], 0
    s_mul_i32 s53, s56, 896
    s_add_u32 m0, s52, 81920
    v_mfma_f32_16x16x32_bf16 v[120:123], v[60:63], a[4:7], 0
    buffer_load_dwordx4 v26, s[24:27], s53 offen lds
    v_mfma_f32_16x16x32_bf16 v[136:139], v[60:63], a[8:11], 0
    v_mfma_f32_16x16x32_bf16 v[152:155], v[60:63], a[12:15], 0
    s_waitcnt lgkmcnt(5)
    v_mfma_f32_16x16x32_bf16 v[100:103], a[248:251], a[0:3], 0
    ds_read_b64_tr_b16 v[56:57], v4 offset:36864
    buffer_load_dwordx4 v27, s[24:27], s53 offen offset:1024 lds
    v_mfma_f32_16x16x32_bf16 v[116:119], a[248:251], a[4:7], 0
    ds_read_b64_tr_b16 v[58:59], v4 offset:37376
    v_mfma_f32_16x16x32_bf16 v[132:135], a[248:251], a[8:11], 0
    ds_read_b64_tr_b16 v[60:61], v4 offset:45056
    v_mfma_f32_16x16x32_bf16 v[148:151], a[248:251], a[12:15], 0
    ds_read_b64_tr_b16 v[62:63], v4 offset:45568
    v_mfma_f32_16x16x32_bf16 v[108:111], a[252:255], a[0:3], 0
    buffer_load_dwordx4 v28, s[24:27], s53 offen offset:2048 lds
    v_mfma_f32_16x16x32_bf16 v[124:127], a[252:255], a[4:7], 0
    s_waitcnt vmcnt(13)
    v_cmp_ne_u32 vcc, 0, v38
    s_nop 0
    s_cmp_eq_u32 vcc_lo, s101
    s_cbranch_scc0 L_slow0
L_ok0:
    v_mfma_f32_16x16x32_bf16 v[140:143], a[252:255], a[8:11], 0
    v_mfma_f32_16x16x32_bf16 v[156:159], a[252:255], a[12:15], 0
    s_waitcnt vmcnt(9) lgkmcnt(7)
    s_barrier
    s_waitcnt lgkmcnt(4)
    v_mfma_f32_16x16x32_bf16 v[96:99], v[48:51], a[16:19], v[96:99]
    ds_read_b64_tr_b16 a[248:249], v3 offset:49152
    buffer_load_dwordx4 v29, s[24:27], s53 offen offset:3072 lds
    v_mfma_f32_16x16x32_bf16 v[112:115], v[48:51], a[20:23], v[112:115]
    ds_read_b64_tr_b16 a[250:251], v3 offset:49664
    ds_read_b64 v[192:193], v23 offset:0
    v_mfma_f32_16x16x32_bf16 v[128:131], v[48:51], a[24:27], v[128:131]
    ds_read_b64_tr_b16 a[252:253], v3 offset:57344
    ds_read_b64 v[194:195], v23 offset:256
    v_mfma_f32_16x16x32_bf16 v[144:147], v[48:51], a[28:31], v[144:147]
    ds_read_b64_tr_b16 a[254:255], v3 offset:57856
    ds_read_b64 v[196:197], v23 offset:512
    v_mfma_f32_16x16x32_bf16 v[104:107], v[52:55], a[16:19], v[104:107]
    s_add_u32 m0, s51, 16384
    ds_read_b64 v[198:199], v23 offset:768
    v_mfma_f32_16x16x32_bf16 v[120:123], v[52:55], a[20:23], v[120:123]
    buffer_load_dwordx4 v5, s[16:19], s67 offen lds
    ds_read_b64 v[200:201], v23 offset:1024
    v_mfma_f32_16x16x32_bf16 v[136:139], v[52:55], a[24:27], v[136:139]
    ds_read_b64 v[202:203], v23 offset:1280
    v_mfma_f32_16x16x32_bf16 v[152:155], v[52:55], a[28:31], v[152:155]
    ds_read_b64 v[204:205], v23 offset:1536
    s_waitcnt lgkmcnt(6)
    v_fma_f32 v194, v14, v192, v194
    v_fma_f32 v195, v14, v193, v195
    v_fma_f32 v194, -v15, v193, v194
    v_mfma_f32_16x16x32_bf16 v[100:103], v[56:59], a[16:19], v[100:103]
    ds_read_b64_tr_b16 v[48:49], v4 offset:49152
    v_fmac_f32 v195, v15, v192
    s_waitcnt lgkmcnt(5)
    v_fma_f32 v196, v14, v194, v196
    v_fma_f32 v197, v14, v195, v197
    v_fma_f32 v196, -v15, v195, v196
    v_mfma_f32_16x16x32_bf16 v[116:119], v[56:59], a[20:23], v[116:119]
    ds_read_b64_tr_b16 v[50:51], v4 offset:49664
    v_fmac_f32 v197, v15, v194
    s_waitcnt lgkmcnt(5)
    v_fma_f32 v198, v14, v196, v198
    v_fma_f32 v199, v14, v197, v199
    v_fma_f32 v198, -v15, v197, v198
    v_mfma_f32_16x16x32_bf16 v[132:135], v[56:59], a[24:27], v[132:135]
    ds_read_b64_tr_b16 v[52:53], v4 offset:57344
    buffer_load_dwordx4 v6, s[16:19], s67 offen offset:1024 lds
    v_mfma_f32_16x16x32_bf16 v[148:151], v[56:59], a[28:31], v[148:151]
    ds_read_b64_tr_b16 v[54:55], v4 offset:57856
    v_fmac_f32 v199, v15, v196
    s_waitcnt lgkmcnt(6)
    v_fma_f32 v200, v14, v198, v200
    v_fma_f32 v201, v14, v199, v201
    v_fma_f32 v200, -v15, v199, v200
    v_mfma_f32_16x16x32_bf16 v[108:111], v[60:63], a[16:19], v[108:111]
    v_fmac_f32 v201, v15, v198
    s_waitcnt lgkmcnt(5)
    v_fma_f32 v202, v14, v200, v202
    v_fma_f32 v203, v14, v201, v203
    v_fma_f32 v202, -v15, v201, v202
    v_fmac_f32 v203, v15, v200
    v_mfma_f32_16x16x32_bf16 v[124:127], v[60:63], a[20:23], v[124:127]
    s_add_u32 m0, s51, 24576
    s_waitcnt lgkmcnt(4)
    v_fma_f32 v36, v14, v202, v204
    v_fma_f32 v37, v14, v203, v205
    v_fma_f32 v36, -v15, v203, v36
    v_mfma_f32_16x16x32_bf16 v[140:143], v[60:63], a[24:27], v[140:143]
    buffer_load_dwordx4 v5, s[20:23], s67 offen lds
    v_mfma_f32_16x16x32_bf16 v[156:159], v[60:63], a[28:31], v[156:159]
    v_fmac_f32 v37, v15, v202
    v_fma_f32 v228, v14, v36, v228
    v_fma_f32 v229, v14, v37, v229
    v_fma_f32 v228, -v15, v37, v228
    v_mfma_f32_16x16x32_bf16 v[96:99], a[248:251], a[32:35], v[96:99]
L_pg1:
    s_cbranch_execz L_back
    ds_read_b64_tr_b16 v[56:57], v3 offset:53248
    v_fmac_f32 v229, v15, v36
    v_min_u32 v228, -2, v228
    v_min_u32 v229, -2, v229
    v_mfma_f32_16x16x32_bf16 v[112:115], a[248:251], a[36:39], v[112:115]
    ds_read_b64_tr_b16 v[58:59], v3 offset:53760
    buffer_store_dwordx2 v[228:229], v40, s[40:43], s85 offen sc1
    v_mfma_f32_16x16x32_bf16 v[128:131], a[248:251], a[40:43], v[128:131]
    ds_read_b64_tr_b16 v[60:61], v3 offset:61440
    v_mfma_f32_16x16x32_bf16 v[144:147], a[248:251], a[44:47], v[144:147]
    ds_read_b64_tr_b16 v[62:63], v3 offset:61952
    buffer_load_dwordx4 v6, s[20:23], s67 offen offset:1024 lds
    v_mfma_f32_16x16x32_bf16 v[104:107], a[252:255], a[32:35], v[104:107]
    v_mfma_f32_16x16x32_bf16 v[120:123], a[252:255], a[36:39], v[120:123]
    v_mfma_f32_16x16x32_bf16 v[136:139], a[252:255], a[40:43], v[136:139]
    s_add_u32 m0, s51, 147456
    v_mfma_f32_16x16x32_bf16 v[152:155], a[252:255], a[44:47], v[152:155]
    buffer_load_dwordx4 v30, s[28:31], s57 offen lds
    s_waitcnt lgkmcnt(4)
    v_mfma_f32_16x16x32_bf16 v[100:103], v[48:51], a[32:35], v[100:103]
    ds_read_b64_tr_b16 a[248:249], v4 offset:53248
    v_mfma_f32_16x16x32_bf16 v[116:119], v[48:51], a[36:39], v[116:119]
    ds_read_b64_tr_b16 a[250:251], v4 offset:53760
    v_mfma_f32_16x16x32_bf16 v[132:135], v[48:51], a[40:43], v[132:135]
    ds_read_b64_tr_b16 a[252:253], v4 offset:61440
    v_mfma_f32_16x16x32_bf16 v[148:151], v[48:51], a[44:47], v[148:151]
    ds_read_b64_tr_b16 a[254:255], v4 offset:61952
    v_mfma_f32_16x16x32_bf16 v[108:111], v[52:55], a[32:35], v[108:111]
    buffer_load_dwordx4 v31, s[28:31], s57 offen offset:1024 lds
    v_mfma_f32_16x16x32_bf16 v[124:127], v[52:55], a[36:39], v[124:127]
    v_mfma_f32_16x16x32_bf16 v[140:143], v[52:55], a[40:43], v[140:143]
    v_mfma_f32_16x16x32_bf16 v[156:159], v[52:55], a[44:47], v[156:159]
    s_waitcnt lgkmcnt(4)
    v_mfma_f32_16x16x32_bf16 v[96:99], v[56:59], a[48:51], v[96:99]
    ds_read_b64_tr_b16 v[48:49], v24 offset:0
    s_add_u32 m0, s51, 98304
    v_mfma_f32_16x16x32_bf16 v[112:115], v[56:59], a[52:55], v[112:115]
    ds_read_b64_tr_b16 v[50:51], v24 offset:512
    buffer_load_dwordx4 v5, s[16:19], s68 offen lds
    v_mfma_f32_16x16x32_bf16 v[128:131], v[56:59], a[56:59], v[128:131]
    ds_read_b64_tr_b16 v[52:53], v24 offset:8192
    v_mul_f32 v230, v13, v64
    v_mfma_f32_16x16x32_bf16 v[144:147], v[56:59], a[60:63], v[144:147]
    ds_read_b64_tr_b16 v[54:55], v24 offset:8704
    v_mul_f32 v64, v12, v64
    v_mfma_f32_16x16x32_bf16 v[104:107], v[60:63], a[48:51], v[104:107]
    v_fmac_f32 v64, v16, v80
    v_mfma_f32_16x16x32_bf16 v[120:123], v[60:63], a[52:55], v[120:123]
    v_fma_f32 v80, v12, v80, v230
    v_mfma_f32_16x16x32_bf16 v[136:139], v[60:63], a[56:59], v[136:139]
    buffer_load_dwordx4 v6, s[16:19], s68 offen offset:1024 lds
    v_mfma_f32_16x16x32_bf16 v[152:155], v[60:63], a[60:63], v[152:155]
    s_waitcnt lgkmcnt(4)
    v_mfma_f32_16x16x32_bf16 v[100:103], a[248:251], a[48:51], v[100:103]
    ds_read_b64_tr_b16 v[56:57], v25 offset:0
    v_mul_f32 v231, v13, v65
    v_mfma_f32_16x16x32_bf16 v[116:119], a[248:251], a[52:55], v[116:119]
    ds_read_b64_tr_b16 v[58:59], v25 offset:512
    s_add_u32 m0, s51, 106496
    v_mfma_f32_16x16x32_bf16 v[132:135], a[248:251], a[56:59], v[132:135]
    ds_read_b64_tr_b16 v[60:61], v25 offset:8192
    buffer_load_dwordx4 v5, s[20:23], s68 offen lds
    v_mfma_f32_16x16x32_bf16 v[148:151], a[248:251], a[60:63], v[148:151]
    ds_read_b64_tr_b16 v[62:63], v25 offset:8704
    v_mfma_f32_16x16x32_bf16 v[108:111], a[252:255], a[48:51], v[108:111]
    v_mul_f32 v65, v12, v65
    v_mfma_f32_16x16x32_bf16 v[124:127], a[252:255], a[52:55], v[124:127]
    v_fmac_f32 v65, v16, v81
    v_mfma_f32_16x16x32_bf16 v[140:143], a[252:255], a[56:59], v[140:143]
    v_fma_f32 v81, v12, v81, v231
    v_mfma_f32_16x16x32_bf16 v[156:159], a[252:255], a[60:63], v[156:159]
    buffer_load_dwordx4 v6, s[20:23], s68 offen offset:1024 lds
    s_waitcnt lgkmcnt(4)
    v_mfma_f32_16x16x32_bf16 v[96:99], v[48:51], a[64:67], v[96:99]
    ds_read_b64_tr_b16 a[248:249], v24 offset:4096
    v_mfma_f32_16x16x32_bf16 v[112:115], v[48:51], a[68:71], v[112:115]
    ds_read_b64_tr_b16 a[250:251], v24 offset:4608
    v_mul_f32 v230, v13, v66
    v_mfma_f32_16x16x32_bf16 v[128:131], v[48:51], a[72:75], v[128:131]
    ds_read_b64_tr_b16 a[252:253], v24 offset:12288
    v_mul_f32 v66, v12, v66
    v_mfma_f32_16x16x32_bf16 v[144:147], v[48:51], a[76:79], v[144:147]
    ds_read_b64_tr_b16 a[254:255], v24 offset:12800
    s_mul_i32 s53, s57, 896
    s_add_u32 m0, s52, 114688
    v_mfma_f32_16x16x32_bf16 v[104:107], v[52:55], a[64:67], v[104:107]
    buffer_load_dwordx4 v26, s[24:27], s53 offen lds
    v_mfma_f32_16x16x32_bf16 v[120:123], v[52:55], a[68:71], v[120:123]
    v_fmac_f32 v66, v16, v82
    v_mfma_f32_16x16x32_bf16 v[136:139], v[52:55], a[72:75], v[136:139]
    v_fma_f32 v82, v12, v82, v230
    v_mfma_f32_16x16x32_bf16 v[152:155], v[52:55], a[76:79], v[152:155]
    s_waitcnt lgkmcnt(4)
    v_mfma_f32_16x16x32_bf16 v[100:103], v[56:59], a[64:67], v[100:103]
    ds_read_b64_tr_b16 v[48:49], v25 offset:4096
    buffer_load_dwordx4 v27, s[24:27], s53 offen offset:1024 lds
    v_mfma_f32_16x16x32_bf16 v[116:119], v[56:59], a[68:71], v[116:119]
    ds_read_b64_tr_b16 v[50:51], v25 offset:4608
    v_mul_f32 v231, v13, v67
    v_mfma_f32_16x16x32_bf16 v[132:135], v[56:59], a[72:75], v[132:135]
    ds_read_b64_tr_b16 v[52:53], v25 offset:12288
    v_mfma_f32_16x16x32_bf16 v[148:151], v[56:59], a[76:79], v[148:151]
    ds_read_b64_tr_b16 v[54:55], v25 offset:12800
    v_mul_f32 v67, v12, v67
    v_mfma_f32_16x16x32_bf16 v[108:111], v[60:63], a[64:67], v[108:111]
    v_fmac_f32 v67, v16, v83
    v_mfma_f32_16x16x32_bf16 v[124:127], v[60:63], a[68:71], v[124:127]
    buffer_load_dwordx4 v28, s[24:27], s53 offen offset:2048 lds
    v_mfma_f32_16x16x32_bf16 v[140:143], v[60:63], a[72:75], v[140:143]
    v_fma_f32 v83, v12, v83, v231
    v_mfma_f32_16x16x32_bf16 v[156:159], v[60:63], a[76:79], v[156:159]
    s_waitcnt vmcnt(9)
    s_barrier
    s_waitcnt lgkmcnt(4)
    v_mfma_f32_16x16x32_bf16 v[96:99], a[248:251], a[80:83], v[96:99]
    ds_read_b64_tr_b16 v[56:57], v3 offset:0
    v_mfma_f32_16x16x32_bf16 v[112:115], a[248:251], a[84:87], v[112:115]
    ds_read_b64_tr_b16 v[58:59], v3 offset:512
    v_mul_f32 v230, v13, v68
    v_mfma_f32_16x16x32_bf16 v[128:131], a[248:251], a[88:91], v[128:131]
    ds_read_b64_tr_b16 v[60:61], v3 offset:8192
    buffer_load_dwordx4 v29, s[24:27], s53 offen offset:3072 lds
    v_mfma_f32_16x16x32_bf16 v[144:147], a[248:251], a[92:95], v[144:147]
    ds_read_b64_tr_b16 v[62:63], v3 offset:8704
    v_mul_f32 v68, v12, v68
    v_mfma_f32_16x16x32_bf16 v[104:107], a[252:255], a[80:83], v[104:107]
    v_add_u32 v32, 0x10000, v32
    ds_read_b64_tr_b16 a[224:225], v32 offset:16384
    v_mfma_f32_16x16x32_bf16 v[120:123], a[252:255], a[84:87], v[120:123]
    ds_read_b64_tr_b16 a[226:227], v32 offset:17408
    v_fmac_f32 v68, v16, v84
    v_mfma_f32_16x16x32_bf16 v[136:139], a[252:255], a[88:91], v[136:139]
    s_add_u32 m0, s51, 32768
    v_add_u32 v33, 0x10000, v33
    ds_read_b64_tr_b16 a[228:229], v33 offset:16384
    v_mfma_f32_16x16x32_bf16 v[152:155], a[252:255], a[92:95], v[152:155]
    buffer_load_dwordx4 v5, s[16:19], s69 offen lds
    s_waitcnt lgkmcnt(7)
    v_mfma_f32_16x16x32_bf16 v[100:103], v[48:51], a[80:83], v[100:103]
    ds_read_b64_tr_b16 a[248:249], v4 offset:0
    v_fma_f32 v84, v12, v84, v230
    v_mfma_f32_16x16x32_bf16 v[116:119], v[48:51], a[84:87], v[116:119]
    ds_read_b64_tr_b16 a[250:251], v4 offset:512
    v_mul_f32 v231, v13, v69
    v_mfma_f32_16x16x32_bf16 v[132:135], v[48:51], a[88:91], v[132:135]
    ds_read_b64_tr_b16 a[252:253], v4 offset:8192
    v_mul_f32 v69, v12, v69
    v_mfma_f32_16x16x32_bf16 v[148:151], v[48:51], a[92:95], v[148:151]
    ds_read_b64_tr_b16 a[254:255], v4 offset:8704
    buffer_load_dwordx4 v6, s[16:19], s69 offen offset:1024 lds
    v_mfma_f32_16x16x32_bf16 v[108:111], v[52:55], a[80:83], v[108:111]
    ds_read_b64_tr_b16 a[230:231], v33 offset:17408
    v_mfma_f32_16x16x32_bf16 v[124:127], v[52:55], a[84:87], v[124:127]
    ds_read_b64_tr_b16 a[232:233], v32 offset:18432
    v_fmac_f32 v69, v16, v85
    v_mfma_f32_16x16x32_bf16 v[140:143], v[52:55], a[88:91], v[140:143]
    ds_read_b64_tr_b16 a[234:235], v32 offset:19456
    v_fma_f32 v85, v12, v85, v231
    v_mfma_f32_16x16x32_bf16 v[156:159], v[52:55], a[92:95], v[156:159]
    s_add_u32 m0, s51, 40960
    s_waitcnt lgkmcnt(10)
    v_mfma_f32_16x16x32_bf16 v[96:99], v[56:59], a[96:99], v[96:99]
    ds_read_b64_tr_b16 v[48:49], v3 offset:4096
    buffer_load_dwordx4 v5, s[20:23], s69 offen lds
    v_mfma_f32_16x16x32_bf16 v[112:115], v[56:59], a[100:103], v[112:115]
    ds_read_b64_tr_b16 v[50:51], v3 offset:4608
    v_mul_f32 v230, v13, v70
    v_mfma_f32_16x16x32_bf16 v[128:131], v[56:59], a[104:107], v[128:131]
    ds_read_b64_tr_b16 v[52:53], v3 offset:12288
    v_mfma_f32_16x16x32_bf16 v[144:147], v[56:59], a[108:111], v[144:147]
    ds_read_b64_tr_b16 v[54:55], v3 offset:12800
    v_mul_f32 v70, v12, v70
    v_mfma_f32_16x16x32_bf16 v[104:107], v[60:63], a[96:99], v[104:107]
    buffer_load_dwordx4 v6, s[20:23], s69 offen offset:1024 lds
    ds_read_b64_tr_b16 a[236:237], v33 offset:18432
    v_mfma_f32_16x16x32_bf16 v[120:123], v[60:63], a[100:103], v[120:123]
    ds_read_b64_tr_b16 a[238:239], v33 offset:19456
    v_fmac_f32 v70, v16, v86
    v_mfma_f32_16x16x32_bf16 v[136:139], v[60:63], a[104:107], v[136:139]
    ds_read_b128 a[240:243], v34 offset:32768
    v_fma_f32 v86, v12, v86, v230
    v_mfma_f32_16x16x32_bf16 v[152:155], v[60:63], a[108:111], v[152:155]
    ds_read_b128 a[244:247], v34 offset:36864
    s_waitcnt lgkmcnt(11)
    v_mfma_f32_16x16x32_bf16 v[100:103], a[248:251], a[96:99], v[100:103]
    ds_read_b64_tr_b16 v[56:57], v4 offset:4096
    v_add_u32 v5, 0x80, v5
    v_add_u32 v6, 0x80, v6
    s_add_u32 m0, s51, 49152
    v_mfma_f32_16x16x32_bf16 v[116:119], a[248:251], a[100:103], v[116:119]
    ds_read_b64_tr_b16 v[58:59], v4 offset:4608
    buffer_load_dwordx4 v5, s[16:19], s63 offen lds
    v_mfma_f32_16x16x32_bf16 v[132:135], a[248:251], a[104:107], v[132:135]
    ds_read_b64_tr_b16 v[60:61], v4 offset:12288
    v_mul_f32 v231, v13, v71
    v_mfma_f32_16x16x32_bf16 v[148:151], a[248:251], a[108:111], v[148:151]
    ds_read_b64_tr_b16 v[62:63], v4 offset:12800
    v_mul_f32 v71, v12, v71
    v_mfma_f32_16x16x32_bf16 v[108:111], a[252:255], a[96:99], v[108:111]
    v_fmac_f32 v71, v16, v87
    v_mfma_f32_16x16x32_bf16 v[124:127], a[252:255], a[100:103], v[124:127]
    v_fma_f32 v87, v12, v87, v231
    v_mfma_f32_16x16x32_bf16 v[140:143], a[252:255], a[104:107], v[140:143]
    buffer_load_dwordx4 v6, s[16:19], s63 offen offset:1024 lds
    v_mfma_f32_16x16x32_bf16 v[156:159], a[252:255], a[108:111], v[156:159]
    v_add_u32 v226, 0xffffff00, v41
    s_waitcnt lgkmcnt(8)
    v_mfma_f32_16x16x32_bf16 v[96:99], v[48:51], a[112:115], v[96:99]
    ds_read_b64_tr_b16 a[248:249], v3 offset:16384
    buffer_load_dwordx2 v[232:233], v41, s[40:43], 0 offen sc1
    v_mfma_f32_16x16x32_bf16 v[112:115], v[48:51], a[116:119], v[112:115]
    ds_read_b64_tr_b16 a[250:251], v3 offset:16896
    buffer_load_dwordx2 v[234:235], v226, s[40:43], 0 offen sc1
    v_mfma_f32_16x16x32_bf16 v[128:131], v[48:51], a[120:123], v[128:131]
    ds_read_b64_tr_b16 a[252:253], v3 offset:24576
    s_add_u32 m0, s51, 57344
    v_mfma_f32_16x16x32_bf16 v[144:147], v[48:51], a[124:127], v[144:147]
    ds_read_b64_tr_b16 a[254:255], v3 offset:25088
    buffer_load_dwordx4 v5, s[20:23], s63 offen lds
    v_mfma_f32_16x16x32_bf16 v[104:107], v[52:55], a[112:115], v[104:107]
    v_mul_f32 v230, v13, v72
    v_mfma_f32_16x16x32_bf16 v[120:123], v[52:55], a[116:119], v[120:123]
    v_mul_f32 v72, v12, v72
    v_mfma_f32_16x16x32_bf16 v[136:139], v[52:55], a[120:123], v[136:139]
    v_fmac_f32 v72, v16, v88
    v_mfma_f32_16x16x32_bf16 v[152:155], v[52:55], a[124:127], v[152:155]
    v_fma_f32 v88, v12, v88, v230
    s_waitcnt lgkmcnt(4)
    v_mfma_f32_16x16x32_bf16 v[100:103], v[56:59], a[112:115], v[100:103]
    ds_read_b64_tr_b16 v[48:49], v4 offset:16384
    buffer_load_dwordx4 v6, s[20:23], s63 offen offset:1024 lds
    v_mfma_f32_16x16x32_bf16 v[116:119], v[56:59], a[116:119], v[116:119]
    ds_read_b64_tr_b16 v[50:51], v4 offset:16896
    v_mul_f32 v231, v13, v73
    v_mfma_f32_16x16x32_bf16 v[132:135], v[56:59], a[120:123], v[132:135]
    ds_read_b64_tr_b16 v[52:53], v4 offset:24576
    v_mul_f32 v73, v12, v73
    v_mfma_f32_16x16x32_bf16 v[148:151], v[56:59], a[124:127], v[148:151]
    ds_read_b64_tr_b16 v[54:55], v4 offset:25088
    s_add_u32 m0, s51, 139264
    v_mfma_f32_16x16x32_bf16 v[108:111], v[60:63], a[112:115], v[108:111]
    buffer_load_dwordx4 v30, s[28:31], s58 offen lds
    v_mfma_f32_16x16x32_bf16 v[124:127], v[60:63], a[116:119], v[124:127]
    v_fmac_f32 v73, v16, v89
    v_mfma_f32_16x16x32_bf16 v[140:143], v[60:63], a[120:123], v[140:143]
    v_fma_f32 v89, v12, v89, v231
    v_mfma_f32_16x16x32_bf16 v[156:159], v[60:63], a[124:127], v[156:159]
    s_waitcnt lgkmcnt(4)
    v_mfma_f32_16x16x32_bf16 v[96:99], a[248:251], a[128:131], v[96:99]
    ds_read_b64_tr_b16 v[56:57], v3 offset:20480
    v_mul_f32 v230, v13, v74
    v_mfma_f32_16x16x32_bf16 v[112:115], a[248:251], a[132:135], v[112:115]
    ds_read_b64_tr_b16 v[58:59], v3 offset:20992
    buffer_load_dwordx4 v31, s[28:31], s58 offen offset:1024 lds
    v_mfma_f32_16x16x32_bf16 v[128:131], a[248:251], a[136:139], v[128:131]
    ds_read_b64_tr_b16 v[60:61], v3 offset:28672
    v_mfma_f32_16x16x32_bf16 v[144:147], a[248:251], a[140:143], v[144:147]
    ds_read_b64_tr_b16 v[62:63], v3 offset:29184
    v_mfma_f32_16x16x32_bf16 v[104:107], a[252:255], a[128:131], v[104:107]
    v_mul_f32 v74, v12, v74
    v_mfma_f32_16x16x32_bf16 v[120:123], a[252:255], a[132:135], v[120:123]
    v_fmac_f32 v74, v16, v90
    v_mfma_f32_16x16x32_bf16 v[136:139], a[252:255], a[136:139], v[136:139]
    v_fma_f32 v90, v12, v90, v230
    v_mfma_f32_16x16x32_bf16 v[152:155], a[252:255], a[140:143], v[152:155]
    s_waitcnt lgkmcnt(4)
    v_mfma_f32_16x16x32_bf16 v[100:103], v[48:51], a[128:131], v[100:103]
    ds_read_b64_tr_b16 a[248:249], v4 offset:20480
    v_mfma_f32_16x16x32_bf16 v[116:119], v[48:51], a[132:135], v[116:119]
    ds_read_b64_tr_b16 a[250:251], v4 offset:20992
    v_mul_f32 v231, v13, v75
    v_mfma_f32_16x16x32_bf16 v[132:135], v[48:51], a[136:139], v[132:135]
    ds_read_b64_tr_b16 a[252:253], v4 offset:28672
    v_mul_f32 v75, v12, v75
    v_mfma_f32_16x16x32_bf16 v[148:151], v[48:51], a[140:143], v[148:151]
    ds_read_b64_tr_b16 a[254:255], v4 offset:29184
    v_fmac_f32 v75, v16, v91
    v_mfma_f32_16x16x32_bf16 v[108:111], v[52:55], a[128:131], v[108:111]
    v_fma_f32 v91, v12, v91, v231
    v_mfma_f32_16x16x32_bf16 v[124:127], v[52:55], a[132:135], v[124:127]
    v_mul_f32 v230, v13, v76
    v_mfma_f32_16x16x32_bf16 v[140:143], v[52:55], a[136:139], v[140:143]
    v_mul_f32 v76, v12, v76
    v_mfma_f32_16x16x32_bf16 v[156:159], v[52:55], a[140:143], v[156:159]
    s_waitcnt vmcnt(16)
    s_barrier
    s_waitcnt lgkmcnt(4)
    v_mfma_f32_16x16x32_bf16 v[96:99], v[56:59], a[144:147], v[96:99]
    ds_read_b64_tr_b16 v[48:49], v24 offset:32768
    s_add_u32 m0, s51, 0
    s_nop 0
    buffer_load_dwordx4 v5, s[16:19], s64 offen lds
    v_and_b32 v227, 0x7c, v254
    v_mfma_f32_16x16x32_bf16 v[112:115], v[56:59], a[148:151], v[112:115]
    ds_read_b64_tr_b16 v[50:51], v24 offset:33280
    buffer_load_dword v38, v227, s[32:35], s71 offen sc1
    v_mfma_f32_16x16x32_bf16 v[128:131], v[56:59], a[152:155], v[128:131]
    ds_read_b64_tr_b16 v[52:53], v24 offset:40960
    v_fmac_f32 v76, v16, v92
    v_mfma_f32_16x16x32_bf16 v[144:147], v[56:59], a[156:159], v[144:147]
    ds_read_b64_tr_b16 v[54:55], v24 offset:41472
    v_fma_f32 v92, v12, v92, v230
    v_mfma_f32_16x16x32_bf16 v[104:107], v[60:63], a[144:147], v[104:107]
    buffer_load_dwordx4 v6, s[16:19], s64 offen offset:1024 lds
    v_mfma_f32_16x16x32_bf16 v[120:123], v[60:63], a[148:151], v[120:123]
    v_mul_f32 v231, v13, v77
    v_mfma_f32_16x16x32_bf16 v[136:139], v[60:63], a[152:155], v[136:139]
    v_mul_f32 v77, v12, v77
    v_mfma_f32_16x16x32_bf16 v[152:155], v[60:63], a[156:159], v[152:155]
    v_fmac_f32 v77, v16, v93
    s_waitcnt lgkmcnt(4)
    v_mfma_f32_16x16x32_bf16 v[100:103], a[248:251], a[144:147], v[100:103]
    ds_read_b64_tr_b16 v[56:57], v25 offset:32768
    s_add_u32 m0, s51, 8192
    v_mfma_f32_16x16x32_bf16 v[116:119], a[248:251], a[148:151], v[116:119]
    ds_read_b64_tr_b16 v[58:59], v25 offset:33280
    buffer_load_dwordx4 v5, s[20:23], s64 offen lds
    v_mfma_f32_16x16x32_bf16 v[132:135], a[248:251], a[152:155], v[132:135]
    ds_read_b64_tr_b16 v[60:61], v25 offset:40960
    v_fma_f32 v93, v12, v93, v231
    v_mfma_f32_16x16x32_bf16 v[148:151], a[248:251], a[156:159], v[148:151]
    ds_read_b64_tr_b16 v[62:63], v25 offset:41472
    v_mul_f32 v230, v13, v78
    v_mfma_f32_16x16x32_bf16 v[108:111], a[252:255], a[144:147], v[108:111]
    s_waitcnt vmcnt(8)
    v_max3_u32 v224, v232, v233, v234
    v_max_u32 v224, v224, v235
    v_cmp_eq_u32 vcc, -1, v224
    s_nop 0
    s_cmp_eq_u64 vcc, 0
    s_cbranch_scc0 L_slow1
L_ok1:
    v_mfma_f32_16x16x32_bf16 v[124:127], a[252:255], a[148:151], v[124:127]
    buffer_load_dwordx4 v6, s[20:23], s64 offen offset:1024 lds
    v_mfma_f32_16x16x32_bf16 v[140:143], a[252:255], a[152:155], v[140:143]
    v_fma_f32 v232, v18, v234, v232
    v_mfma_f32_16x16x32_bf16 v[156:159], a[252:255], a[156:159], v[156:159]
    v_fma_f32 v233, v18, v235, v233
    s_waitcnt lgkmcnt(4)
    v_mfma_f32_16x16x32_bf16 v[96:99], v[48:51], a[160:163], v[96:99]
    ds_read_b64_tr_b16 a[248:249], v24 offset:36864
    v_fma_f32 v232, -v19, v235, v232
    v_mfma_f32_16x16x32_bf16 v[112:115], v[48:51], a[164:167], v[112:115]
    ds_read_b64_tr_b16 a[250:251], v24 offset:37376
    s_mul_i32 s53, s58, 896
    s_add_u32 m0, s52, 65536
    v_mfma_f32_16x16x32_bf16 v[128:131], v[48:51], a[168:171], v[128:131]
    ds_read_b64_tr_b16 a[252:253], v24 offset:45056
    buffer_load_dwordx4 v26, s[24:27], s53 offen lds
    v_mfma_f32_16x16x32_bf16 v[144:147], v[48:51], a[172:175], v[144:147]
    ds_read_b64_tr_b16 a[254:255], v24 offset:45568
    v_fmac_f32 v233, v19, v234
    v_mfma_f32_16x16x32_bf16 v[104:107], v[52:55], a[160:163], v[104:107]
    ds_write_b64 v23, v[232:233] offset:4096
    v_and_b32 v224, 0xff, v23
    v_mfma_f32_16x16x32_bf16 v[120:123], v[52:55], a[164:167], v[120:123]
    v_add_u32 v224, 161792, v224
    v_mfma_f32_16x16x32_bf16 v[136:139], v[52:55], a[168:171], v[136:139]
    buffer_load_dwordx4 v27, s[24:27], s53 offen offset:1024 lds
    v_mfma_f32_16x16x32_bf16 v[152:155], v[52:55], a[172:175], v[152:155]
    v_mul_f32 v78, v12, v78
    s_waitcnt lgkmcnt(5)
    v_mfma_f32_16x16x32_bf16 v[100:103], v[56:59], a[160:163], v[100:103]
    ds_read_b64_tr_b16 v[48:49], v25 offset:36864
    v_fmac_f32 v78, v16, v94
    v_mfma_f32_16x16x32_bf16 v[116:119], v[56:59], a[164:167], v[116:119]
    ds_read_b64_tr_b16 v[50:51], v25 offset:37376
    v_fma_f32 v94, v12, v94, v230
    v_mfma_f32_16x16x32_bf16 v[132:135], v[56:59], a[168:171], v[132:135]
    ds_read_b64_tr_b16 v[52:53], v25 offset:45056
    v_mul_f32 v231, v13, v79
    v_mfma_f32_16x16x32_bf16 v[148:151], v[56:59], a[172:175], v[148:151]
    ds_read_b64_tr_b16 v[54:55], v25 offset:45568
    buffer_load_dwordx4 v28, s[24:27], s53 offen offset:2048 lds
    v_mfma_f32_16x16x32_bf16 v[108:111], v[60:63], a[160:163], v[108:111]
    v_mul_f32 v79, v12, v79
    v_mfma_f32_16x16x32_bf16 v[124:127], v[60:63], a[164:167], v[124:127]
    v_fmac_f32 v79, v16, v95
    v_mfma_f32_16x16x32_bf16 v[140:143], v[60:63], a[168:171], v[140:143]
    v_fma_f32 v95, v12, v95, v231
    v_mfma_f32_16x16x32_bf16 v[156:159], v[60:63], a[172:175], v[156:159]
    s_waitcnt lgkmcnt(4)
    s_barrier
    v_mfma_f32_16x16x32_bf16 v[96:99], a[248:251], a[176:179], v[96:99]
    ds_read_b64_tr_b16 v[56:57], v3 offset:32768
    buffer_load_dwordx4 v29, s[24:27], s53 offen offset:3072 lds
    v_mfma_f32_16x16x32_bf16 v[112:115], a[248:251], a[180:183], v[112:115]
    ds_read_b64_tr_b16 v[58:59], v3 offset:33280
    v_mfma_f32_16x16x32_bf16 v[128:131], a[248:251], a[184:187], v[128:131]
    ds_read_b64_tr_b16 v[60:61], v3 offset:40960
    v_mfma_f32_16x16x32_bf16 v[144:147], a[248:251], a[188:191], v[144:147]
    ds_read_b64_tr_b16 v[62:63], v3 offset:41472
    v_mfma_f32_16x16x32_bf16 v[104:107], a[252:255], a[176:179], v[104:107]
    s_add_u32 m0, s51, 16384
    ds_read_b64 v[232:233], v224 offset:1792
    v_mfma_f32_16x16x32_bf16 v[120:123], a[252:255], a[180:183], v[120:123]
    buffer_load_dwordx4 v5, s[16:19], s65 offen lds
    ds_read_b64 v[234:235], v224 offset:1536
    v_mfma_f32_16x16x32_bf16 v[136:139], a[252:255], a[184:187], v[136:139]
    ds_read_b64 v[236:237], v224 offset:1280
    v_mfma_f32_16x16x32_bf16 v[152:155], a[252:255], a[188:191], v[152:155]
    ds_read_b64 v[238:239], v224 offset:1024
    s_waitcnt lgkmcnt(8)
    v_mfma_f32_16x16x32_bf16 v[100:103], v[48:51], a[176:179], v[100:103]
    ds_read_b64_tr_b16 a[248:249], v4 offset:32768
    v_mfma_f32_16x16x32_bf16 v[116:119], v[48:51], a[180:183], v[116:119]
    ds_read_b64_tr_b16 a[250:251], v4 offset:33280
    v_mfma_f32_16x16x32_bf16 v[132:135], v[48:51], a[184:187], v[132:135]
    ds_read_b64_tr_b16 a[252:253], v4 offset:40960
    buffer_load_dwordx4 v6, s[16:19], s65 offen offset:1024 lds
    v_mfma_f32_16x16x32_bf16 v[148:151], v[48:51], a[188:191], v[148:151]
    ds_read_b64_tr_b16 a[254:255], v4 offset:41472
    v_mfma_f32_16x16x32_bf16 v[108:111], v[52:55], a[176:179], v[108:111]
    s_waitcnt vmcnt(9)
    v_cmp_eq_u32 vcc, -1, v38
    s_nop 0
    s_cmp_eq_u64 vcc, 0
    s_cbranch_scc0 L_slow2
L_ok2:
    v_mfma_f32_16x16x32_bf16 v[124:127], v[52:55], a[180:183], v[124:127]
    s_add_u32 m0, s51, 24576
    ds_read_b64 v[240:241], v224 offset:768
    v_sub_f32 v227, 1.0, v38
    v_mfma_f32_16x16x32_bf16 v[140:143], v[52:55], a[184:187], v[140:143]
    buffer_load_dwordx4 v5, s[20:23], s65 offen lds
    ds_read_b64 v[242:243], v224 offset:512
    v_mfma_f32_16x16x32_bf16 v[156:159], v[52:55], a[188:191], v[156:159]
    ds_read_b64 v[244:245], v224 offset:256
    v_cvt_pk_bf16_f32 v227, v227, v227
    s_waitcnt lgkmcnt(11)
    v_mfma_f32_16x16x32_bf16 v[96:99], v[56:59], a[192:195], v[96:99]
    ds_read_b64_tr_b16 v[48:49], v3 offset:36864
    v_lshlrev_b32 v227, 16, v227
    v_mfma_f32_16x16x32_bf16 v[112:115], v[56:59], a[196:199], v[112:115]
    ds_read_b64_tr_b16 v[50:51], v3 offset:37376
    s_mov_b32 vcc_lo, 0
    s_mov_b32 vcc_hi, -1
    v_cndmask_b32 v227, v38, v227, vcc
    v_mfma_f32_16x16x32_bf16 v[128:131], v[56:59], a[200:203], v[128:131]
    ds_read_b64_tr_b16 v[52:53], v3 offset:45056
    ds_write_b32 v8, v227
    v_mfma_f32_16x16x32_bf16 v[144:147], v[56:59], a[204:207], v[144:147]
    ds_read_b64_tr_b16 v[54:55], v3 offset:45568
    buffer_load_dwordx4 v6, s[20:23], s65 offen offset:1024 lds
    v_mfma_f32_16x16x32_bf16 v[104:107], v[60:63], a[192:195], v[104:107]
    ds_read_b64 v[246:247], v224 offset:0
    s_waitcnt lgkmcnt(15)
    v_fma_f32 v234, v17, v232, v234
    v_fma_f32 v235, v17, v233, v235
    v_fma_f32 v234, -v20, v233, v234
    v_mfma_f32_16x16x32_bf16 v[120:123], v[60:63], a[196:199], v[120:123]
    v_fmac_f32 v235, v20, v232
    s_waitcnt lgkmcnt(14)
    v_fma_f32 v236, v17, v234, v236
    v_fma_f32 v237, v17, v235, v237
    v_mfma_f32_16x16x32_bf16 v[136:139], v[60:63], a[200:203], v[136:139]
    s_add_u32 m0, s51, 81920
    v_fma_f32 v236, -v20, v235, v236
    v_fmac_f32 v237, v20, v234
    v_mfma_f32_16x16x32_bf16 v[152:155], v[60:63], a[204:207], v[152:155]
    buffer_load_dwordx4 v5, s[16:19], s66 offen lds
    s_waitcnt lgkmcnt(9)
    v_mfma_f32_16x16x32_bf16 v[100:103], a[248:251], a[192:195], v[100:103]
    ds_read_b64_tr_b16 v[56:57], v4 offset:36864
    v_fma_f32 v238, v17, v236, v238
    v_fma_f32 v239, v17, v237, v239
    v_mfma_f32_16x16x32_bf16 v[116:119], a[248:251], a[196:199], v[116:119]
    ds_read_b64_tr_b16 v[58:59], v4 offset:37376
    v_fma_f32 v238, -v20, v237, v238
    v_fmac_f32 v239, v20, v236
    v_mfma_f32_16x16x32_bf16 v[132:135], a[248:251], a[200:203], v[132:135]
    ds_read_b64_tr_b16 v[60:61], v4 offset:45056
    s_waitcnt lgkmcnt(11)
    v_fma_f32 v240, v17, v238, v240
    v_fma_f32 v241, v17, v239, v241
    v_mfma_f32_16x16x32_bf16 v[148:151], a[248:251], a[204:207], v[148:151]
    ds_read_b64_tr_b16 v[62:63], v4 offset:45568
    v_fma_f32 v240, -v20, v239, v240
    v_fmac_f32 v241, v20, v238
    v_mfma_f32_16x16x32_bf16 v[108:111], a[252:255], a[192:195], v[108:111]
    buffer_load_dwordx4 v6, s[16:19], s66 offen offset:1024 lds
    v_mfma_f32_16x16x32_bf16 v[124:127], a[252:255], a[196:199], v[124:127]
    s_waitcnt lgkmcnt(11)
    v_fma_f32 v242, v17, v240, v242
    v_fma_f32 v243, v17, v241, v243
    v_fma_f32 v242, -v20, v241, v242
    v_mfma_f32_16x16x32_bf16 v[140:143], a[252:255], a[200:203], v[140:143]
    v_fmac_f32 v243, v20, v240
    s_waitcnt lgkmcnt(10)
    v_fma_f32 v244, v17, v242, v244
    v_fma_f32 v245, v17, v243, v245
    v_mfma_f32_16x16x32_bf16 v[156:159], a[252:255], a[204:207], v[156:159]
    s_waitcnt lgkmcnt(6)
    s_barrier
    s_waitcnt lgkmcnt(5)
    v_mfma_f32_16x16x32_bf16 v[96:99], v[48:51], a[208:211], v[96:99]
    ds_read_b64_tr_b16 a[248:249], v3 offset:49152
    s_add_u32 m0, s51, 90112
    v_fma_f32 v244, -v20, v243, v244
    v_mfma_f32_16x16x32_bf16 v[112:115], v[48:51], a[212:215], v[112:115]
    ds_read_b64_tr_b16 a[250:251], v3 offset:49664
    buffer_load_dwordx4 v5, s[20:23], s66 offen lds
    v_mfma_f32_16x16x32_bf16 v[128:131], v[48:51], a[216:219], v[128:131]
    ds_read_b64_tr_b16 a[252:253], v3 offset:57344
    v_fmac_f32 v245, v20, v242
    s_waitcnt lgkmcnt(7)
    v_fma_f32 v246, v17, v244, v246
    v_mfma_f32_16x16x32_bf16 v[144:147], v[48:51], a[220:223], v[144:147]
    ds_read_b64_tr_b16 a[254:255], v3 offset:57856
    v_fma_f32 v247, v17, v245, v247
    v_fma_f32 v246, -v20, v245, v246
    v_mfma_f32_16x16x32_bf16 v[104:107], v[52:55], a[208:211], v[104:107]
    ds_read_b32 v18, v39 offset:0
    v_fmac_f32 v247, v20, v244
    v_fma_f32 v36, v21, v246, v36
    v_mfma_f32_16x16x32_bf16 v[120:123], v[52:55], a[212:215], v[120:123]
    ds_read_b32 v19, v39 offset:16
    v_fma_f32 v37, v21, v247, v37
    v_fma_f32 v36, -v22, v247, v36
    v_mfma_f32_16x16x32_bf16 v[136:139], v[52:55], a[216:219], v[136:139]
    ds_read_b32 v14, v39 offset:32
    v_fmac_f32 v37, v22, v246
    v_mul_f32 v224, v12, v36
    v_mfma_f32_16x16x32_bf16 v[152:155], v[52:55], a[220:223], v[152:155]
    ds_read_b32 v15, v39 offset:48
    v_mul_f32 v225, v12, v37
    s_waitcnt lgkmcnt(8)
    v_mfma_f32_16x16x32_bf16 v[100:103], v[56:59], a[208:211], v[100:103]
    ds_read_b64_tr_b16 v[48:49], v4 offset:49152
    buffer_load_dwordx4 v6, s[20:23], s66 offen offset:1024 lds
    v_mfma_f32_16x16x32_bf16 v[116:119], v[56:59], a[212:215], v[116:119]
    ds_read_b64_tr_b16 v[50:51], v4 offset:49664
    v_fma_f32 v224, -v13, v37, v224
    v_fmac_f32 v225, v13, v36
    v_mfma_f32_16x16x32_bf16 v[132:135], v[56:59], a[216:219], v[132:135]
    ds_read_b64_tr_b16 v[52:53], v4 offset:57344
    v_fmac_f32 v64, v9, v224
    v_fmac_f32 v80, v9, v225
    v_mfma_f32_16x16x32_bf16 v[148:151], v[56:59], a[220:223], v[148:151]
    ds_read_b64_tr_b16 v[54:55], v4 offset:57856
    v_fmac_f32 v64, v11, v225
    v_fmac_f32 v80, v10, v224
    v_mfma_f32_16x16x32_bf16 v[108:111], v[60:63], a[208:211], v[108:111]
    v_fmac_f32 v65, v9, v64
    v_fmac_f32 v81, v9, v80
    v_fmac_f32 v65, v11, v80
    v_mfma_f32_16x16x32_bf16 v[124:127], v[60:63], a[212:215], v[124:127]
    v_fmac_f32 v81, v10, v64
    v_fmac_f32 v66, v9, v65
    v_fmac_f32 v82, v9, v81
    v_mfma_f32_16x16x32_bf16 v[140:143], v[60:63], a[216:219], v[140:143]
    s_add_u32 m0, s51, 131072
    v_fmac_f32 v66, v11, v81
    v_fmac_f32 v82, v10, v65
    v_mfma_f32_16x16x32_bf16 v[156:159], v[60:63], a[220:223], v[156:159]
    buffer_load_dwordx4 v30, s[28:31], s59 offen lds
    s_waitcnt lgkmcnt(8)
    v_mfma_f32_16x16x32_bf16 v[160:163], a[248:251], a[0:3], 0
    ds_read_b64_tr_b16 v[56:57], v3 offset:53248
    v_fmac_f32 v67, v9, v66
    v_fmac_f32 v83, v9, v82
    v_mfma_f32_16x16x32_bf16 v[176:179], a[248:251], a[4:7], 0
    ds_read_b64_tr_b16 v[58:59], v3 offset:53760
    v_fmac_f32 v67, v11, v82
    v_fmac_f32 v83, v10, v66
    v_mfma_f32_16x16x32_bf16 v[192:195], a[248:251], a[8:11], 0
    ds_read_b64_tr_b16 v[60:61], v3 offset:61440
    s_waitcnt lgkmcnt(10)
    v_mul_f32 v96, v18, v96
    v_mul_f32 v97, v18, v97
    v_mfma_f32_16x16x32_bf16 v[208:211], a[248:251], a[12:15], 0
    ds_read_b64_tr_b16 v[62:63], v3 offset:61952
    v_mul_f32 v98, v18, v98
    v_mul_f32 v99, v18, v99
    v_mfma_f32_16x16x32_bf16 v[168:171], a[252:255], a[0:3], 0
    v_mul_f32 v100, v18, v100
    v_mul_f32 v101, v18, v101
    v_mul_f32 v102, v18, v102
    v_mfma_f32_16x16x32_bf16 v[184:187], a[252:255], a[4:7], 0
    v_mul_f32 v103, v18, v103
    v_mul_f32 v96, v96, v104
    v_mul_f32 v97, v97, v105
    v_mfma_f32_16x16x32_bf16 v[200:203], a[252:255], a[8:11], 0
    buffer_load_dwordx4 v31, s[28:31], s59 offen offset:1024 lds
    v_mfma_f32_16x16x32_bf16 v[216:219], a[252:255], a[12:15], 0
    v_mul_f32 v98, v98, v106
L_pg2:
    s_cbranch_execz L_back
    v_mul_f32 v99, v99, v107
    v_fmac_f32 v68, v9, v67
    s_waitcnt lgkmcnt(4)
    v_mfma_f32_16x16x32_bf16 v[164:167], v[48:51], a[0:3], 0
    ds_read_b64_tr_b16 a[248:249], v4 offset:53248
    v_mul_f32 v100, v100, v108
    v_mul_f32 v101, v101, v109
    v_fmac_f32 v84, v9, v83
    v_mfma_f32_16x16x32_bf16 v[180:183], v[48:51], a[4:7], 0
    ds_read_b64_tr_b16 a[250:251], v4 offset:53760
    v_mul_f32 v102, v102, v110
    v_mul_f32 v103, v103, v111
    v_fmac_f32 v68, v11, v83
    v_mfma_f32_16x16x32_bf16 v[196:199], v[48:51], a[8:11], 0
    ds_read_b64_tr_b16 a[252:253], v4 offset:61440
    v_cvt_pk_bf16_f32 v104, v96, v97
    v_cvt_pk_bf16_f32 v105, v98, v99
    v_fmac_f32 v84, v10, v67
    v_mfma_f32_16x16x32_bf16 v[212:215], v[48:51], a[12:15], 0
    ds_read_b64_tr_b16 a[254:255], v4 offset:61952
    v_cvt_pk_bf16_f32 v106, v100, v101
    v_cvt_pk_bf16_f32 v107, v102, v103
    v_fmac_f32 v69, v9, v68
    v_mfma_f32_16x16x32_bf16 v[172:175], v[52:55], a[0:3], 0
    s_add_u32 m0, s51, 98304
    buffer_store_dwordx4 v[104:107], v7, s[32:35], s77 offen offset:0 sc1
    v_mfma_f32_16x16x32_bf16 v[188:191], v[52:55], a[4:7], 0
    buffer_load_dwordx4 v5, s[16:19], s67 offen lds
    v_mfma_f32_16x16x32_bf16 v[204:207], v[52:55], a[8:11], 0
    v_mul_f32 v112, v19, v112
    v_mul_f32 v113, v19, v113
    v_mul_f32 v114, v19, v114
    v_fmac_f32 v85, v9, v84
    v_mfma_f32_16x16x32_bf16 v[220:223], v[52:55], a[12:15], 0
    s_waitcnt vmcnt(16)
    s_barrier
    s_waitcnt lgkmcnt(4)
    v_mfma_f32_16x16x32_bf16 v[160:163], v[56:59], a[16:19], v[160:163]
    ds_read_b64_tr_b16 v[48:49], v3 offset:0
    v_mul_f32 v115, v19, v115
    v_mul_f32 v116, v19, v116
    v_mul_f32 v117, v19, v117
    v_mfma_f32_16x16x32_bf16 v[176:179], v[56:59], a[20:23], v[176:179]
    ds_read_b64_tr_b16 v[50:51], v3 offset:512
    v_mul_f32 v118, v19, v118
    v_mul_f32 v119, v19, v119
    v_fmac_f32 v69, v11, v84
    v_mfma_f32_16x16x32_bf16 v[192:195], v[56:59], a[24:27], v[192:195]
    ds_read_b64_tr_b16 v[52:53], v3 offset:8192
    v_mul_f32 v112, v112, v120
    v_mul_f32 v113, v113, v121
    v_mul_f32 v114, v114, v122
    v_mfma_f32_16x16x32_bf16 v[208:211], v[56:59], a[28:31], v[208:211]
    ds_read_b64_tr_b16 v[54:55], v3 offset:8704
    v_mul_f32 v115, v115, v123
    v_mul_f32 v116, v116, v124
    v_mul_f32 v117, v117, v125
    v_mfma_f32_16x16x32_bf16 v[168:171], v[60:63], a[16:19], v[168:171]
    ds_read_b128 v[232:235], v251 offset:0
    v_mul_f32 v118, v118, v126
    v_mul_f32 v119, v119, v127
    v_cvt_pk_bf16_f32 v120, v112, v113
    v_mfma_f32_16x16x32_bf16 v[184:187], v[60:63], a[20:23], v[184:187]
    buffer_load_dwordx4 v6, s[16:19], s67 offen offset:1024 lds
    ds_read_b128 v[236:239], v251 offset:16
    v_mfma_f32_16x16x32_bf16 v[200:203], v[60:63], a[24:27], v[200:203]
    ds_read_b128 v[240:243], v251 offset:32
    v_cvt_pk_bf16_f32 v121, v114, v115
    v_cvt_pk_bf16_f32 v122, v116, v117
    v_cvt_pk_bf16_f32 v123, v118, v119
    v_mfma_f32_16x16x32_bf16 v[216:219], v[60:63], a[28:31], v[216:219]
    ds_read_b128 v[244:247], v251 offset:48
    buffer_store_dwordx4 v[120:123], v7, s[32:35], s77 offen offset:256 sc1
    s_waitcnt lgkmcnt(8)
    v_mfma_f32_16x16x32_bf16 v[164:167], a[248:251], a[16:19], v[164:167]
    ds_read_b64_tr_b16 v[56:57], v4 offset:0
    v_mul_f32 v128, v14, v128
    v_mul_f32 v129, v14, v129
    v_fmac_f32 v85, v10, v68
    v_mfma_f32_16x16x32_bf16 v[180:183], a[248:251], a[20:23], v[180:183]
    ds_read_b64_tr_b16 v[58:59], v4 offset:512
    v_mul_f32 v130, v14, v130
    v_mul_f32 v131, v14, v131
    v_fmac_f32 v70, v9, v69
    v_mfma_f32_16x16x32_bf16 v[196:199], a[248:251], a[24:27], v[196:199]
    ds_read_b64_tr_b16 v[60:61], v4 offset:8192
    v_mul_f32 v132, v14, v132
    v_mul_f32 v133, v14, v133
    v_mfma_f32_16x16x32_bf16 v[212:215], a[248:251], a[28:31], v[212:215]
    ds_read_b64_tr_b16 v[62:63], v4 offset:8704
    s_add_u32 m0, s51, 106496
    v_mul_f32 v134, v14, v134
    v_mfma_f32_16x16x32_bf16 v[172:175], a[252:255], a[16:19], v[172:175]
    buffer_load_dwordx4 v5, s[20:23], s67 offen lds
    v_mfma_f32_16x16x32_bf16 v[188:191], a[252:255], a[20:23], v[188:191]
    v_mul_f32 v135, v14, v135
    v_mul_f32 v128, v128, v136
    v_mul_f32 v129, v129, v137
    v_mfma_f32_16x16x32_bf16 v[204:207], a[252:255], a[24:27], v[204:207]
    v_mul_f32 v130, v130, v138
    v_mul_f32 v131, v131, v139
    v_mul_f32 v132, v132, v140
    v_mfma_f32_16x16x32_bf16 v[220:223], a[252:255], a[28:31], v[220:223]
    v_mul_f32 v133, v133, v141
    v_mul_f32 v134, v134, v142
    s_waitcnt lgkmcnt(8)
    v_mfma_f32_16x16x32_bf16 v[160:163], v[48:51], a[32:35], v[160:163]
    ds_read_b64_tr_b16 a[248:249], v3 offset:4096
    v_mul_f32 v135, v135, v143
    v_cvt_pk_bf16_f32 v136, v128, v129
    v_mfma_f32_16x16x32_bf16 v[176:179], v[48:51], a[36:39], v[176:179]
    ds_read_b64_tr_b16 a[250:251], v3 offset:4608
    v_cvt_pk_bf16_f32 v137, v130, v131
    v_cvt_pk_bf16_f32 v138, v132, v133
    v_cvt_pk_bf16_f32 v139, v134, v135
    v_mfma_f32_16x16x32_bf16 v[192:195], v[48:51], a[40:43], v[192:195]
    ds_read_b64_tr_b16 a[252:253], v3 offset:12288
    buffer_store_dwordx4 v[136:139], v7, s[32:35], s78 offen offset:0 sc1
    v_mfma_f32_16x16x32_bf16 v[208:211], v[48:51], a[44:47], v[208:211]
    ds_read_b64_tr_b16 a[254:255], v3 offset:12800
    buffer_load_dwordx4 v6, s[20:23], s67 offen offset:1024 lds
    v_mfma_f32_16x16x32_bf16 v[168:171], v[52:55], a[32:35], v[168:171]
    v_mul_f32 v144, v15, v144
    v_mul_f32 v145, v15, v145
    v_fmac_f32 v86, v9, v85
    v_mfma_f32_16x16x32_bf16 v[184:187], v[52:55], a[36:39], v[184:187]
    v_mul_f32 v146, v15, v146
    v_mul_f32 v147, v15, v147
    v_mul_f32 v148, v15, v148
    v_mfma_f32_16x16x32_bf16 v[200:203], v[52:55], a[40:43], v[200:203]
    v_mul_f32 v149, v15, v149
    v_mul_f32 v150, v15, v150
    v_mul_f32 v151, v15, v151
    v_mfma_f32_16x16x32_bf16 v[216:219], v[52:55], a[44:47], v[216:219]
    v_mul_f32 v144, v144, v152
    v_mul_f32 v145, v145, v153
    s_waitcnt lgkmcnt(4)
    v_mfma_f32_16x16x32_bf16 v[164:167], v[56:59], a[32:35], v[164:167]
    ds_read_b64_tr_b16 v[48:49], v4 offset:4096
    s_mul_i32 s53, s59, 896
    s_add_u32 m0, s52, 32768
    v_mfma_f32_16x16x32_bf16 v[180:183], v[56:59], a[36:39], v[180:183]
    ds_read_b64_tr_b16 v[50:51], v4 offset:4608
    buffer_load_dwordx4 v26, s[24:27], s53 offen lds
    v_mfma_f32_16x16x32_bf16 v[196:199], v[56:59], a[40:43], v[196:199]
    ds_read_b64_tr_b16 v[52:53], v4 offset:12288
    v_mul_f32 v146, v146, v154
    v_mul_f32 v147, v147, v155
    v_mfma_f32_16x16x32_bf16 v[212:215], v[56:59], a[44:47], v[212:215]
    ds_read_b64_tr_b16 v[54:55], v4 offset:12800
    v_mul_f32 v148, v148, v156
    v_mul_f32 v149, v149, v157
    v_mfma_f32_16x16x32_bf16 v[172:175], v[60:63], a[32:35], v[172:175]
    v_mul_f32 v150, v150, v158
    v_mul_f32 v151, v151, v159
    v_cvt_pk_bf16_f32 v152, v144, v145
    v_mfma_f32_16x16x32_bf16 v[188:191], v[60:63], a[36:39], v[188:191]
    v_cvt_pk_bf16_f32 v153, v146, v147
    v_cvt_pk_bf16_f32 v154, v148, v149
    v_cvt_pk_bf16_f32 v155, v150, v151
    v_mfma_f32_16x16x32_bf16 v[204:207], v[60:63], a[40:43], v[204:207]
    buffer_store_dwordx4 v[152:155], v7, s[32:35], s78 offen offset:256 sc1
    v_mfma_f32_16x16x32_bf16 v[220:223], v[60:63], a[44:47], v[220:223]
    s_waitcnt vmcnt(15)
    s_barrier
    s_waitcnt lgkmcnt(4)
    v_mfma_f32_16x16x32_bf16 v[160:163], a[248:251], a[48:51], v[160:163]
    ds_read_b64_tr_b16 v[56:57], v3 offset:16384
    v_fmac_f32 v70, v11, v85
    v_fmac_f32 v86, v10, v69
    v_mfma_f32_16x16x32_bf16 v[176:179], a[248:251], a[52:55], v[176:179]
    ds_read_b64_tr_b16 v[58:59], v3 offset:16896
    buffer_load_dwordx4 v27, s[24:27], s53 offen offset:1024 lds
    v_mfma_f32_16x16x32_bf16 v[192:195], a[248:251], a[56:59], v[192:195]
    ds_read_b64_tr_b16 v[60:61], v3 offset:24576
    v_fmac_f32 v71, v9, v70
    v_fmac_f32 v87, v9, v86
    v_mfma_f32_16x16x32_bf16 v[208:211], a[248:251], a[60:63], v[208:211]
    ds_read_b64_tr_b16 v[62:63], v3 offset:25088
    v_fmac_f32 v71, v11, v86
    v_fmac_f32 v87, v10, v70
    v_mfma_f32_16x16x32_bf16 v[168:171], a[252:255], a[48:51], v[168:171]
    ds_read_b64_tr_b16 a[0:1], v32 offset:49152
    v_fmac_f32 v72, v9, v71
    v_fmac_f32 v88, v9, v87
    v_mfma_f32_16x16x32_bf16 v[184:187], a[252:255], a[52:55], v[184:187]
    ds_read_b64_tr_b16 a[2:3], v32 offset:50176
    v_fmac_f32 v72, v11, v87
    v_fmac_f32 v88, v10, v71
    v_mfma_f32_16x16x32_bf16 v[200:203], a[252:255], a[56:59], v[200:203]
    buffer_load_dwordx4 v28, s[24:27], s53 offen offset:2048 lds
    ds_read_b64_tr_b16 a[4:5], v33 offset:49152
    v_mfma_f32_16x16x32_bf16 v[216:219], a[252:255], a[60:63], v[216:219]
    ds_read_b64_tr_b16 a[6:7], v33 offset:50176
    v_fmac_f32 v73, v9, v72
    s_waitcnt lgkmcnt(8)
    v_mfma_f32_16x16x32_bf16 v[164:167], v[48:51], a[48:51], v[164:167]
    ds_read_b64_tr_b16 a[248:249], v4 offset:16384
    v_fmac_f32 v89, v9, v88
    v_fmac_f32 v73, v11, v88
    v_mfma_f32_16x16x32_bf16 v[180:183], v[48:51], a[52:55], v[180:183]
    ds_read_b64_tr_b16 a[250:251], v4 offset:16896
    v_fmac_f32 v89, v10, v72
    v_fmac_f32 v74, v9, v73
    v_mfma_f32_16x16x32_bf16 v[196:199], v[48:51], a[56:59], v[196:199]
    ds_read_b64_tr_b16 a[252:253], v4 offset:24576
    buffer_load_dwordx4 v29, s[24:27], s53 offen offset:3072 lds
    v_mfma_f32_16x16x32_bf16 v[212:215], v[48:51], a[60:63], v[212:215]
    ds_read_b64_tr_b16 a[254:255], v4 offset:25088
    v_fmac_f32 v90, v9, v89
    v_fmac_f32 v74, v11, v89
    v_mfma_f32_16x16x32_bf16 v[172:175], v[52:55], a[48:51], v[172:175]
    ds_read_b64_tr_b16 a[8:9], v32 offset:51200
    v_fmac_f32 v90, v10, v73
    v_fmac_f32 v75, v9, v74
    v_mfma_f32_16x16x32_bf16 v[188:191], v[52:55], a[52:55], v[188:191]
    ds_read_b64_tr_b16 a[10:11], v32 offset:52224
    v_fmac_f32 v91, v9, v90
    v_fmac_f32 v75, v11, v90
    v_mfma_f32_16x16x32_bf16 v[204:207], v[52:55], a[56:59], v[204:207]
    s_add_u32 m0, s51, 49152
    ds_read_b64_tr_b16 a[12:13], v33 offset:51200
    v_fmac_f32 v91, v10, v74
    v_mfma_f32_16x16x32_bf16 v[220:223], v[52:55], a[60:63], v[220:223]
    buffer_load_dwordx4 v5, s[16:19], s68 offen lds
    s_waitcnt lgkmcnt(11)
    v_mfma_f32_16x16x32_bf16 v[160:163], v[56:59], a[64:67], v[160:163]
    ds_read_b64_tr_b16 v[48:49], v3 offset:20480
    v_fmac_f32 v76, v9, v75
    v_fmac_f32 v92, v9, v91
    v_mfma_f32_16x16x32_bf16 v[176:179], v[56:59], a[68:71], v[176:179]
    ds_read_b64_tr_b16 v[50:51], v3 offset:20992
    v_fmac_f32 v76, v11, v91
    v_fmac_f32 v92, v10, v75
    v_mfma_f32_16x16x32_bf16 v[192:195], v[56:59], a[72:75], v[192:195]
    ds_read_b64_tr_b16 v[52:53], v3 offset:28672
    v_fmac_f32 v77, v9, v76
    v_fmac_f32 v93, v9, v92
    v_mfma_f32_16x16x32_bf16 v[208:211], v[56:59], a[76:79], v[208:211]
    ds_read_b64_tr_b16 v[54:55], v3 offset:29184
    v_fmac_f32 v77, v11, v92
    v_fmac_f32 v93, v10, v76
    v_mfma_f32_16x16x32_bf16 v[168:171], v[60:63], a[64:67], v[168:171]
    buffer_load_dwordx4 v6, s[16:19], s68 offen offset:1024 lds
    ds_read_b64_tr_b16 a[14:15], v33 offset:52224
    v_mfma_f32_16x16x32_bf16 v[184:187], v[60:63], a[68:71], v[184:187]
    ds_read_b128 a[16:19], v34 offset:49152
    v_fmac_f32 v78, v9, v77
    v_fmac_f32 v94, v9, v93
    v_mfma_f32_16x16x32_bf16 v[200:203], v[60:63], a[72:75], v[200:203]
    ds_read_b128 a[20:23], v34 offset:53248
    v_fmac_f32 v78, v11, v93
    v_fmac_f32 v94, v10, v77
    v_mfma_f32_16x16x32_bf16 v[216:219], v[60:63], a[76:79], v[216:219]
    s_add_u32 m0, s51, 57344
    v_fmac_f32 v79, v9, v78
    s_waitcnt lgkmcnt(10)
    v_mfma_f32_16x16x32_bf16 v[164:167], a[248:251], a[64:67], v[164:167]
    ds_read_b64_tr_b16 v[56:57], v4 offset:20480
    buffer_load_dwordx4 v5, s[20:23], s68 offen lds
    v_mfma_f32_16x16x32_bf16 v[180:183], a[248:251], a[68:71], v[180:183]
    ds_read_b64_tr_b16 v[58:59], v4 offset:20992
    v_fmac_f32 v95, v9, v94
    v_fmac_f32 v79, v11, v94
    v_mfma_f32_16x16x32_bf16 v[196:199], a[248:251], a[72:75], v[196:199]
    ds_read_b64_tr_b16 v[60:61], v4 offset:28672
    v_fmac_f32 v95, v10, v78
    v_mul_f32 v64, v232, v64
    v_mfma_f32_16x16x32_bf16 v[212:215], a[248:251], a[76:79], v[212:215]
    ds_read_b64_tr_b16 v[62:63], v4 offset:29184
    v_mul_f32 v80, v232, v80
    v_mul_f32 v65, v233, v65
    v_mfma_f32_16x16x32_bf16 v[172:175], a[252:255], a[64:67], v[172:175]
    v_mul_f32 v81, v233, v81
    v_mul_f32 v66, v234, v66
    v_mul_f32 v82, v234, v82
    v_mfma_f32_16x16x32_bf16 v[188:191], a[252:255], a[68:71], v[188:191]
    buffer_load_dwordx4 v6, s[20:23], s68 offen offset:1024 lds
    v_mfma_f32_16x16x32_bf16 v[204:207], a[252:255], a[72:75], v[204:207]
    v_mul_f32 v67, v235, v67
    v_mul_f32 v83, v235, v83
    v_mul_f32 v68, v236, v68
    v_mfma_f32_16x16x32_bf16 v[220:223], a[252:255], a[76:79], v[220:223]
    s_waitcnt vmcnt(18) lgkmcnt(4)
    s_barrier
    v_mfma_f32_16x16x32_bf16 v[160:163], v[48:51], a[80:83], v[160:163]
    ds_read_b64_tr_b16 a[248:249], v24 offset:16384
    v_mul_f32 v84, v236, v84
    v_mul_f32 v69, v237, v69
    v_mfma_f32_16x16x32_bf16 v[176:179], v[48:51], a[84:87], v[176:179]
    ds_read_b64_tr_b16 a[250:251], v24 offset:16896
    s_add_u32 m0, s51, 0
    v_mul_f32 v85, v237, v85
    v_mfma_f32_16x16x32_bf16 v[192:195], v[48:51], a[88:91], v[192:195]
    ds_read_b64_tr_b16 a[252:253], v24 offset:24576
    buffer_load_dwordx4 v5, s[16:19], s69 offen lds
    v_mfma_f32_16x16x32_bf16 v[208:211], v[48:51], a[92:95], v[208:211]
    ds_read_b64_tr_b16 a[254:255], v24 offset:25088
    v_mul_f32 v70, v238, v70
    v_mul_f32 v86, v238, v86
    v_mfma_f32_16x16x32_bf16 v[168:171], v[52:55], a[80:83], v[168:171]
    ds_read_b64_tr_b16 a[24:25], v32 offset:0
    v_mul_f32 v71, v239, v71
    v_mul_f32 v87, v239, v87
    v_mfma_f32_16x16x32_bf16 v[184:187], v[52:55], a[84:87], v[184:187]
    ds_read_b64_tr_b16 a[26:27], v32 offset:1024
    v_mul_f32 v72, v240, v72
    v_mul_f32 v88, v240, v88
    v_mfma_f32_16x16x32_bf16 v[200:203], v[52:55], a[88:91], v[200:203]
    ds_read_b64_tr_b16 a[28:29], v33 offset:0
    v_mul_f32 v73, v241, v73
    v_mul_f32 v89, v241, v89
    v_mfma_f32_16x16x32_bf16 v[216:219], v[52:55], a[92:95], v[216:219]
    buffer_load_dwordx4 v6, s[16:19], s69 offen offset:1024 lds
    s_waitcnt lgkmcnt(7)
    v_mfma_f32_16x16x32_bf16 v[164:167], v[56:59], a[80:83], v[164:167]
    ds_read_b64_tr_b16 v[48:49], v25 offset:16384
    v_mul_f32 v74, v242, v74
    v_mul_f32 v90, v242, v90
    v_mfma_f32_16x16x32_bf16 v[180:183], v[56:59], a[84:87], v[180:183]
    ds_read_b64_tr_b16 v[50:51], v25 offset:16896
    v_mul_f32 v75, v243, v75
    v_mul_f32 v91, v243, v91
    v_mfma_f32_16x16x32_bf16 v[196:199], v[56:59], a[88:91], v[196:199]
    ds_read_b64_tr_b16 v[52:53], v25 offset:24576
    s_add_u32 m0, s51, 8192
    v_mul_f32 v76, v244, v76
    v_mfma_f32_16x16x32_bf16 v[212:215], v[56:59], a[92:95], v[212:215]
    ds_read_b64_tr_b16 v[54:55], v25 offset:25088
    buffer_load_dwordx4 v5, s[20:23], s69 offen lds
    v_mfma_f32_16x16x32_bf16 v[172:175], v[60:63], a[80:83], v[172:175]
    ds_read_b64_tr_b16 a[30:31], v33 offset:1024
    v_mul_f32 v92, v244, v92
    v_mul_f32 v77, v245, v77
    v_mfma_f32_16x16x32_bf16 v[188:191], v[60:63], a[84:87], v[188:191]
    ds_read_b64_tr_b16 a[32:33], v32 offset:2048
    v_mul_f32 v93, v245, v93
    v_mul_f32 v78, v246, v78
    v_mfma_f32_16x16x32_bf16 v[204:207], v[60:63], a[88:91], v[204:207]
    ds_read_b64_tr_b16 a[34:35], v32 offset:3072
    v_mul_f32 v94, v246, v94
    v_mul_f32 v79, v247, v79
    v_mfma_f32_16x16x32_bf16 v[220:223], v[60:63], a[92:95], v[220:223]
    ds_read_b64_tr_b16 a[36:37], v33 offset:2048
    v_mul_f32 v95, v247, v95
    s_waitcnt lgkmcnt(11)
    v_mfma_f32_16x16x32_bf16 v[160:163], a[248:251], a[96:99], v[160:163]
    ds_read_b64_tr_b16 v[56:57], v24 offset:20480
    buffer_load_dwordx4 v6, s[20:23], s69 offen offset:1024 lds
    v_mfma_f32_16x16x32_bf16 v[176:179], a[248:251], a[100:103], v[176:179]
    ds_read_b64_tr_b16 v[58:59], v24 offset:20992
    v_cvt_pk_bf16_f32 v64, v64, v65
    v_cvt_pk_bf16_f32 v65, v66, v67
    v_mfma_f32_16x16x32_bf16 v[192:195], a[248:251], a[104:107], v[192:195]
    ds_read_b64_tr_b16 v[60:61], v24 offset:28672
    v_cvt_pk_bf16_f32 v66, v68, v69
    v_cvt_pk_bf16_f32 v67, v70, v71
    v_mfma_f32_16x16x32_bf16 v[208:211], a[248:251], a[108:111], v[208:211]
    ds_read_b64_tr_b16 v[62:63], v24 offset:29184
    s_mul_i32 s53, s60, 896
    s_add_u32 m0, s52, 114688
    v_mfma_f32_16x16x32_bf16 v[168:171], a[252:255], a[96:99], v[168:171]
    buffer_load_dwordx4 v26, s[24:27], s53 offen lds
    ds_read_b64_tr_b16 a[38:39], v33 offset:3072
    v_mfma_f32_16x16x32_bf16 v[184:187], a[252:255], a[100:103], v[184:187]
    ds_read_b128 a[40:43], v34 offset:40960
    v_cvt_pk_bf16_f32 v68, v72, v73
    v_cvt_pk_bf16_f32 v69, v74, v75
    v_mfma_f32_16x16x32_bf16 v[200:203], a[252:255], a[104:107], v[200:203]
    ds_read_b128 a[44:47], v34 offset:45056
    v_cvt_pk_bf16_f32 v70, v76, v77
    v_cvt_pk_bf16_f32 v71, v78, v79
    v_mfma_f32_16x16x32_bf16 v[216:219], a[252:255], a[108:111], v[216:219]
    v_cvt_pk_bf16_f32 v72, -v80, -v81
    v_cvt_pk_bf16_f32 v73, -v82, -v83
    s_waitcnt lgkmcnt(11)
    v_mfma_f32_16x16x32_bf16 v[164:167], v[48:51], a[96:99], v[164:167]
    ds_read_b64_tr_b16 a[248:249], v25 offset:20480
    v_cvt_pk_bf16_f32 v74, -v84, -v85
    v_cvt_pk_bf16_f32 v75, -v86, -v87
    v_mfma_f32_16x16x32_bf16 v[180:183], v[48:51], a[100:103], v[180:183]
    ds_read_b64_tr_b16 a[250:251], v25 offset:20992
    buffer_load_dwordx4 v27, s[24:27], s53 offen offset:1024 lds
    v_mfma_f32_16x16x32_bf16 v[196:199], v[48:51], a[104:107], v[196:199]
    ds_read_b64_tr_b16 a[252:253], v25 offset:28672
    v_cvt_pk_bf16_f32 v76, -v88, -v89
    v_cvt_pk_bf16_f32 v77, -v90, -v91
    v_mfma_f32_16x16x32_bf16 v[212:215], v[48:51], a[108:111], v[212:215]
    ds_read_b64_tr_b16 a[254:255], v25 offset:29184
    v_cvt_pk_bf16_f32 v78, -v92, -v93
    v_cvt_pk_bf16_f32 v79, -v94, -v95
    v_mfma_f32_16x16x32_bf16 v[172:175], v[52:55], a[96:99], v[172:175]
    v_mov_b32 v224, 0
    v_mov_b32 v225, 0
    v_mov_b32 v226, v44
    v_mfma_f32_16x16x32_bf16 v[188:191], v[52:55], a[100:103], v[188:191]
    v_mov_b32 v227, v45
    v_mov_b32 v228, 0
    v_mov_b32 v229, 0
    v_mfma_f32_16x16x32_bf16 v[204:207], v[52:55], a[104:107], v[204:207]
    buffer_load_dwordx4 v28, s[24:27], s53 offen offset:2048 lds
    v_mfma_f32_16x16x32_bf16 v[220:223], v[52:55], a[108:111], v[220:223]
    s_waitcnt vmcnt(14) lgkmcnt(4)
    s_barrier
    v_mfma_f32_16x16x32_bf16 v[96:99], v[64:67], v[226:229], 0
    v_mfma_f32_16x16x32_bf16 v[100:103], v[64:67], v[224:227], 0
    v_mfma_f32_16x16x32_bf16 v[160:163], v[56:59], a[112:115], v[160:163]
    ds_read_b64_tr_b16 v[48:49], v24 offset:32768
    buffer_store_dword v35, v2, s[32:35], s80 offen offset:4 sc1
    s_add_u32 s80, s80, 32768
    v_mfma_f32_16x16x32_bf16 v[112:115], v[68:71], v[226:229], 0
    v_mfma_f32_16x16x32_bf16 v[116:119], v[68:71], v[224:227], 0
    v_mfma_f32_16x16x32_bf16 v[176:179], v[56:59], a[116:119], v[176:179]
    ds_read_b64_tr_b16 v[50:51], v24 offset:33280
    v_mfma_f32_16x16x32_bf16 v[128:131], v[72:75], v[226:229], 0
    v_mfma_f32_16x16x32_bf16 v[132:135], v[72:75], v[224:227], 0
    v_mfma_f32_16x16x32_bf16 v[192:195], v[56:59], a[120:123], v[192:195]
    ds_read_b64_tr_b16 v[52:53], v24 offset:40960
    v_mfma_f32_16x16x32_bf16 v[144:147], v[76:79], v[226:229], 0
    v_mfma_f32_16x16x32_bf16 v[148:151], v[76:79], v[224:227], 0
    v_mfma_f32_16x16x32_bf16 v[208:211], v[56:59], a[124:127], v[208:211]
    ds_read_b64_tr_b16 v[54:55], v24 offset:41472
    buffer_load_dwordx4 v29, s[24:27], s53 offen offset:3072 lds
    v_mfma_f32_16x16x32_bf16 v[168:171], v[60:63], a[112:115], v[168:171]
    v_cvt_pk_bf16_f32 v80, v96, v97
    v_mfma_f32_16x16x32_bf16 v[184:187], v[60:63], a[116:119], v[184:187]
    v_cvt_pk_bf16_f32 v81, v98, v99
    v_mfma_f32_16x16x32_bf16 v[200:203], v[60:63], a[120:123], v[200:203]
    v_cvt_pk_bf16_f32 v82, v100, v101
    v_mfma_f32_16x16x32_bf16 v[216:219], v[60:63], a[124:127], v[216:219]
    v_cvt_pk_bf16_f32 v83, v102, v103
    s_waitcnt lgkmcnt(4)
    v_mfma_f32_16x16x32_bf16 v[164:167], a[248:251], a[112:115], v[164:167]
    ds_read_b64_tr_b16 v[56:57], v25 offset:32768
    s_add_u32 m0, s51, 147456
    global_load_dwordx2 v[68:69], v250, s[86:87]
    v_mfma_f32_16x16x32_bf16 v[180:183], a[248:251], a[116:119], v[180:183]
    ds_read_b64_tr_b16 v[58:59], v25 offset:33280
    buffer_load_dwordx4 v30, s[28:31], s60 offen lds
    s_mov_b32 s55, 0
    buffer_load_dwordx2 v[70:71], v248, s[4:7], s55 offen
    v_mfma_f32_16x16x32_bf16 v[196:199], a[248:251], a[120:123], v[196:199]
    ds_read_b64_tr_b16 v[60:61], v25 offset:40960
    ds_read_b32 v9, v249 offset:0
    v_permlane16_swap_b32 v80, v82
    v_mfma_f32_16x16x32_bf16 v[212:215], a[248:251], a[124:127], v[212:215]
    ds_read_b64_tr_b16 v[62:63], v25 offset:41472
    s_mov_b32 s55, 3584
    buffer_load_dwordx2 v[72:73], v248, s[4:7], s55 offen
    v_permlane16_swap_b32 v81, v83
    v_mfma_f32_16x16x32_bf16 v[172:175], a[252:255], a[112:115], v[172:175]
    buffer_store_dwordx4 v[80:83], v1, s[32:35], s79 offen offset:2048 sc1
    s_add_u32 s79, s79, 0x2a000
    ds_read_b32 v10, v249 offset:16
    v_mfma_f32_16x16x32_bf16 v[188:191], a[252:255], a[116:119], v[188:191]
    s_mov_b32 s55, 7168
    buffer_load_dwordx2 v[74:75], v248, s[4:7], s55 offen
    v_cvt_pk_bf16_f32 v84, v112, v113
    v_mfma_f32_16x16x32_bf16 v[204:207], a[252:255], a[120:123], v[204:207]
    ds_read_b32 v11, v249 offset:32
    v_cvt_pk_bf16_f32 v85, v114, v115
    v_mfma_f32_16x16x32_bf16 v[220:223], a[252:255], a[124:127], v[220:223]
    s_mov_b32 s55, 10752
    buffer_load_dwordx2 v[76:77], v248, s[4:7], s55 offen
    v_cvt_pk_bf16_f32 v86, v116, v117
    s_waitcnt lgkmcnt(7)
    v_mfma_f32_16x16x32_bf16 v[160:163], v[48:51], a[128:131], v[160:163]
    ds_read_b64_tr_b16 a[248:249], v24 offset:36864
    buffer_load_dwordx4 v31, s[28:31], s60 offen offset:1024 lds
    ds_read_b32 v12, v249 offset:48
    v_mfma_f32_16x16x32_bf16 v[176:179], v[48:51], a[132:135], v[176:179]
    ds_read_b64_tr_b16 a[250:251], v24 offset:37376
    v_cvt_pk_bf16_f32 v87, v118, v119
    v_mfma_f32_16x16x32_bf16 v[192:195], v[48:51], a[136:139], v[192:195]
    ds_read_b64_tr_b16 a[252:253], v24 offset:45056
    v_permlane16_swap_b32 v84, v86
    v_mfma_f32_16x16x32_bf16 v[208:211], v[48:51], a[140:143], v[208:211]
    ds_read_b64_tr_b16 a[254:255], v24 offset:45568
    v_permlane16_swap_b32 v85, v87
    v_mfma_f32_16x16x32_bf16 v[168:171], v[52:55], a[128:131], v[168:171]
    buffer_store_dwordx4 v[84:87], v1, s[32:35], s79 offen offset:2048 sc1
    v_mfma_f32_16x16x32_bf16 v[184:187], v[52:55], a[132:135], v[184:187]
    s_mul_i32 s53, s61, 896
    s_add_u32 m0, s52, 65536
    v_mfma_f32_16x16x32_bf16 v[200:203], v[52:55], a[136:139], v[200:203]
    buffer_load_dwordx4 v26, s[24:27], s53 offen lds
    s_add_u32 s79, s79, 0xfffeb000
    v_mfma_f32_16x16x32_bf16 v[216:219], v[52:55], a[140:143], v[216:219]
    v_cvt_pk_bf16_f32 v88, v128, v129
    s_waitcnt lgkmcnt(7)
    v_mfma_f32_16x16x32_bf16 v[164:167], v[56:59], a[128:131], v[164:167]
    ds_read_b64_tr_b16 v[48:49], v25 offset:36864
    v_cvt_pk_bf16_f32 v89, v130, v131
    v_mfma_f32_16x16x32_bf16 v[180:183], v[56:59], a[132:135], v[180:183]
    ds_read_b64_tr_b16 v[50:51], v25 offset:37376
    v_cvt_pk_bf16_f32 v90, v132, v133
    v_mfma_f32_16x16x32_bf16 v[196:199], v[56:59], a[136:139], v[196:199]
    ds_read_b64_tr_b16 v[52:53], v25 offset:45056
    v_cvt_pk_bf16_f32 v91, v134, v135
    v_mfma_f32_16x16x32_bf16 v[212:215], v[56:59], a[140:143], v[212:215]
    ds_read_b64_tr_b16 v[54:55], v25 offset:45568
    v_permlane16_swap_b32 v88, v90
    v_mfma_f32_16x16x32_bf16 v[172:175], v[60:63], a[128:131], v[172:175]
    buffer_load_dwordx4 v27, s[24:27], s53 offen offset:1024 lds
    v_mfma_f32_16x16x32_bf16 v[188:191], v[60:63], a[132:135], v[188:191]
    v_permlane16_swap_b32 v89, v91
    v_mfma_f32_16x16x32_bf16 v[204:207], v[60:63], a[136:139], v[204:207]
    buffer_store_dwordx4 v[88:91], v1, s[32:35], s79 offen offset:2048 sc1
    s_add_u32 s79, s79, 0x2a000
    v_mfma_f32_16x16x32_bf16 v[220:223], v[60:63], a[140:143], v[220:223]
    s_waitcnt vmcnt(21)
    s_barrier
    s_waitcnt lgkmcnt(4)
    v_mfma_f32_16x16x32_bf16 v[160:163], a[248:251], a[144:147], v[160:163]
    ds_read_b64_tr_b16 v[56:57], v3 offset:49152
    v_cvt_pk_bf16_f32 v92, v144, v145
    v_mfma_f32_16x16x32_bf16 v[176:179], a[248:251], a[148:151], v[176:179]
    ds_read_b64_tr_b16 v[58:59], v3 offset:49664
    v_cvt_pk_bf16_f32 v93, v146, v147
    v_mfma_f32_16x16x32_bf16 v[192:195], a[248:251], a[152:155], v[192:195]
    ds_read_b64_tr_b16 v[60:61], v3 offset:57344
    v_cvt_pk_bf16_f32 v94, v148, v149
    v_mfma_f32_16x16x32_bf16 v[208:211], a[248:251], a[156:159], v[208:211]
    ds_read_b64_tr_b16 v[62:63], v3 offset:57856
    buffer_load_dwordx4 v28, s[24:27], s53 offen offset:2048 lds
    v_mfma_f32_16x16x32_bf16 v[168:171], a[252:255], a[144:147], v[168:171]
    v_add_u32 v32, 0xffff8000, v32
    ds_read_b64_tr_b16 a[48:49], v32 offset:0
    v_cvt_pk_bf16_f32 v95, v150, v151
    v_mfma_f32_16x16x32_bf16 v[184:187], a[252:255], a[148:151], v[184:187]
    ds_read_b64_tr_b16 a[50:51], v32 offset:1024
    v_permlane16_swap_b32 v92, v94
    v_mfma_f32_16x16x32_bf16 v[200:203], a[252:255], a[152:155], v[200:203]
    v_add_u32 v33, 0xffff8000, v33
    ds_read_b64_tr_b16 a[52:53], v33 offset:0
    v_permlane16_swap_b32 v93, v95
    v_mfma_f32_16x16x32_bf16 v[216:219], a[252:255], a[156:159], v[216:219]
    ds_read_b64_tr_b16 a[54:55], v33 offset:1024
    buffer_store_dwordx4 v[92:95], v1, s[32:35], s79 offen offset:2048 sc1
    s_waitcnt lgkmcnt(8)
    v_mfma_f32_16x16x32_bf16 v[164:167], v[48:51], a[144:147], v[164:167]
    ds_read_b64_tr_b16 a[248:249], v4 offset:49152
    v_add_u32 v5, s91, v1
    v_mfma_f32_16x16x32_bf16 v[180:183], v[48:51], a[148:151], v[180:183]
    ds_read_b64_tr_b16 a[250:251], v4 offset:49664
    buffer_load_dwordx4 v29, s[24:27], s53 offen offset:3072 lds
    v_mfma_f32_16x16x32_bf16 v[196:199], v[48:51], a[152:155], v[196:199]
    ds_read_b64_tr_b16 a[252:253], v4 offset:57344
    s_mul_i32 s63, s56, 96
    v_mfma_f32_16x16x32_bf16 v[212:215], v[48:51], a[156:159], v[212:215]
    ds_read_b64_tr_b16 a[254:255], v4 offset:57856
    s_mul_i32 s64, s57, 96
    v_mfma_f32_16x16x32_bf16 v[172:175], v[52:55], a[144:147], v[172:175]
    ds_read_b64_tr_b16 a[56:57], v32 offset:2048
    v_add_u32 v6, s92, v1
    v_mfma_f32_16x16x32_bf16 v[188:191], v[52:55], a[148:151], v[188:191]
    ds_read_b64_tr_b16 a[58:59], v32 offset:3072
    s_mul_i32 s65, s58, 96
    v_mfma_f32_16x16x32_bf16 v[204:207], v[52:55], a[152:155], v[204:207]
    ds_read_b64_tr_b16 a[60:61], v33 offset:2048
    v_mfma_f32_16x16x32_bf16 v[220:223], v[52:55], a[156:159], v[220:223]
    s_add_u32 m0, s51, 139264
    s_waitcnt lgkmcnt(11)
    v_mfma_f32_16x16x32_bf16 v[160:163], v[56:59], a[160:163], v[160:163]
    ds_read_b64_tr_b16 v[48:49], v3 offset:53248
    buffer_load_dwordx4 v30, s[28:31], s61 offen lds
    v_mfma_f32_16x16x32_bf16 v[176:179], v[56:59], a[164:167], v[176:179]
    ds_read_b64_tr_b16 v[50:51], v3 offset:53760
    s_mul_i32 s66, s59, 96
    s_waitcnt vmcnt(15)
    v_lshlrev_b32 v64, 16, v68
    v_and_b32 v65, 0xffff0000, v68
    v_mfma_f32_16x16x32_bf16 v[192:195], v[56:59], a[168:171], v[192:195]
    ds_read_b64_tr_b16 v[52:53], v3 offset:61440
    v_lshlrev_b32 v66, 16, v69
    v_and_b32 v67, 0xffff0000, v69
    s_waitcnt vmcnt(13)
    v_lshlrev_b32 v224, 16, v70
    v_mfma_f32_16x16x32_bf16 v[208:211], v[56:59], a[172:175], v[208:211]
    ds_read_b64_tr_b16 v[54:55], v3 offset:61952
    v_and_b32 v225, 0xffff0000, v70
    v_lshlrev_b32 v226, 16, v71
    v_mfma_f32_16x16x32_bf16 v[168:171], v[60:63], a[160:163], v[168:171]
    ds_read_b64_tr_b16 a[62:63], v33 offset:3072
    s_mul_i32 s67, s60, 96
    v_and_b32 v227, 0xffff0000, v71
    v_mfma_f32_16x16x32_bf16 v[184:187], v[60:63], a[164:167], v[184:187]
    ds_read_b128 a[64:67], v34 offset:32768
    v_mul_f32 v224, v224, v64
    v_mul_f32 v225, v225, v65
    v_mfma_f32_16x16x32_bf16 v[200:203], v[60:63], a[168:171], v[200:203]
    buffer_load_dwordx4 v31, s[28:31], s61 offen offset:1024 lds
    ds_read_b128 a[68:71], v34 offset:36864
    v_mfma_f32_16x16x32_bf16 v[216:219], v[60:63], a[172:175], v[216:219]
    v_mul_f32 v226, v226, v66
    v_mul_f32 v227, v227, v67
    v_cvt_pk_bf16_f32 v70, v224, v225
    s_waitcnt lgkmcnt(10)
    v_mfma_f32_16x16x32_bf16 v[164:167], a[248:251], a[160:163], v[164:167]
    ds_read_b64_tr_b16 v[56:57], v4 offset:53248
    v_cvt_pk_bf16_f32 v71, v226, v227
    v_lshlrev_b32 v224, 16, v70
    v_mfma_f32_16x16x32_bf16 v[180:183], a[248:251], a[164:167], v[180:183]
    ds_read_b64_tr_b16 v[58:59], v4 offset:53760
    s_mul_i32 s68, s61, 96
    v_and_b32 v225, 0xffff0000, v70
    v_lshlrev_b32 v226, 16, v71
    v_mfma_f32_16x16x32_bf16 v[196:199], a[248:251], a[168:171], v[196:199]
L_pg3:
    s_cbranch_execz L_back
    ds_read_b64_tr_b16 v[60:61], v4 offset:61440
    v_and_b32 v227, 0xffff0000, v71
    v_mul_f32 v224, v224, v9
    v_mfma_f32_16x16x32_bf16 v[212:215], a[248:251], a[172:175], v[212:215]
    ds_read_b64_tr_b16 v[62:63], v4 offset:61952
    s_mul_i32 s53, s62, 896
    s_add_u32 m0, s52, 81920
    v_mul_f32 v225, v225, v9
    v_mfma_f32_16x16x32_bf16 v[172:175], a[252:255], a[160:163], v[172:175]
    buffer_load_dwordx4 v26, s[24:27], s53 offen lds
    buffer_load_dword v38, v42, s[32:35], s81 offen offset:4 sc1
    v_mfma_f32_16x16x32_bf16 v[188:191], a[252:255], a[164:167], v[188:191]
    s_mul_i32 s69, s62, 96
    v_add_u32 v8, s93, v1
    v_mul_f32 v226, v226, v9
    v_mul_f32 v227, v227, v9
    v_mfma_f32_16x16x32_bf16 v[204:207], a[252:255], a[168:171], v[204:207]
    v_add_u32 v23, s94, v1
    s_waitcnt vmcnt(15)
    v_lshlrev_b32 v228, 16, v72
    v_and_b32 v229, 0xffff0000, v72
    v_mfma_f32_16x16x32_bf16 v[220:223], a[252:255], a[172:175], v[220:223]
    s_waitcnt lgkmcnt(4)
    s_barrier
    v_mfma_f32_16x16x32_bf16 v[160:163], v[48:51], a[176:179], v[160:163]
    ds_read_b64_tr_b16 a[248:249], v3 offset:0
    v_lshlrev_b32 v230, 16, v73
    v_and_b32 v231, 0xffff0000, v73
    v_mfma_f32_16x16x32_bf16 v[176:179], v[48:51], a[180:183], v[176:179]
    ds_read_b64_tr_b16 a[250:251], v3 offset:512
    v_mul_f32 v228, v228, v64
    v_mul_f32 v229, v229, v65
    v_mfma_f32_16x16x32_bf16 v[192:195], v[48:51], a[184:187], v[192:195]
    ds_read_b64_tr_b16 a[252:253], v3 offset:8192
    v_mul_f32 v230, v230, v66
    v_mul_f32 v231, v231, v67
    v_mfma_f32_16x16x32_bf16 v[208:211], v[48:51], a[188:191], v[208:211]
    ds_read_b64_tr_b16 a[254:255], v3 offset:8704
    buffer_load_dwordx4 v27, s[24:27], s53 offen offset:1024 lds
    v_mfma_f32_16x16x32_bf16 v[168:171], v[52:55], a[176:179], v[168:171]
    v_and_b32 v41, 0xf0, v1
    v_cvt_pk_bf16_f32 v72, v228, v229
    v_cvt_pk_bf16_f32 v73, v230, v231
    v_mfma_f32_16x16x32_bf16 v[184:187], v[52:55], a[180:183], v[184:187]
    v_lshlrev_b32 v228, 16, v72
    v_and_b32 v229, 0xffff0000, v72
    v_lshlrev_b32 v230, 16, v73
    v_mfma_f32_16x16x32_bf16 v[200:203], v[52:55], a[184:187], v[200:203]
    v_and_b32 v231, 0xffff0000, v73
    v_mul_f32 v228, v228, v10
    v_mul_f32 v229, v229, v10
    v_mfma_f32_16x16x32_bf16 v[216:219], v[52:55], a[188:191], v[216:219]
    v_mul_f32 v230, v230, v10
    v_mul_f32 v231, v231, v10
    s_waitcnt lgkmcnt(4)
    v_mfma_f32_16x16x32_bf16 v[164:167], v[56:59], a[176:179], v[164:167]
    ds_read_b64_tr_b16 v[48:49], v4 offset:0
    s_waitcnt vmcnt(14)
    v_lshlrev_b32 v232, 16, v74
    v_and_b32 v233, 0xffff0000, v74
    v_mfma_f32_16x16x32_bf16 v[180:183], v[56:59], a[180:183], v[180:183]
    ds_read_b64_tr_b16 v[50:51], v4 offset:512
    buffer_load_dwordx4 v28, s[24:27], s53 offen offset:2048 lds
    v_mfma_f32_16x16x32_bf16 v[196:199], v[56:59], a[184:187], v[196:199]
    ds_read_b64_tr_b16 v[52:53], v4 offset:8192
    v_lshlrev_b32 v234, 16, v75
    v_and_b32 v235, 0xffff0000, v75
    v_mfma_f32_16x16x32_bf16 v[212:215], v[56:59], a[188:191], v[212:215]
    ds_read_b64_tr_b16 v[54:55], v4 offset:8704
    v_mul_f32 v232, v232, v64
    v_mul_f32 v233, v233, v65
    v_mfma_f32_16x16x32_bf16 v[172:175], v[60:63], a[176:179], v[172:175]
    v_and_b32 v40, 0x300, v1
    v_mul_f32 v234, v234, v66
    v_mul_f32 v235, v235, v67
    v_mfma_f32_16x16x32_bf16 v[188:191], v[60:63], a[180:183], v[188:191]
    v_cvt_pk_bf16_f32 v74, v232, v233
    v_cvt_pk_bf16_f32 v75, v234, v235
    v_lshlrev_b32 v232, 16, v74
    v_mfma_f32_16x16x32_bf16 v[204:207], v[60:63], a[184:187], v[204:207]
    v_lshl_add_u32 v41, v40, 1, v41
    v_and_b32 v233, 0xffff0000, v74
    v_lshlrev_b32 v234, 16, v75
    v_mfma_f32_16x16x32_bf16 v[220:223], v[60:63], a[188:191], v[220:223]
    v_and_b32 v235, 0xffff0000, v75
    v_mul_f32 v232, v232, v11
    s_waitcnt lgkmcnt(4)
    v_mfma_f32_16x16x32_bf16 v[160:163], a[248:251], a[192:195], v[160:163]
    ds_read_b64_tr_b16 v[56:57], v3 offset:4096
    buffer_load_dwordx4 v29, s[24:27], s53 offen offset:3072 lds
    v_mfma_f32_16x16x32_bf16 v[176:179], a[248:251], a[196:199], v[176:179]
    ds_read_b64_tr_b16 v[58:59], v3 offset:4608
    v_mul_f32 v233, v233, v11
    v_mul_f32 v234, v234, v11
    v_mfma_f32_16x16x32_bf16 v[192:195], a[248:251], a[200:203], v[192:195]
    ds_read_b64_tr_b16 v[60:61], v3 offset:12288
    v_mul_f32 v235, v235, v11
    s_waitcnt vmcnt(15)
    v_lshlrev_b32 v236, 16, v76
    v_mfma_f32_16x16x32_bf16 v[208:211], a[248:251], a[204:207], v[208:211]
    ds_read_b64_tr_b16 v[62:63], v3 offset:12800
    v_and_b32 v237, 0xffff0000, v76
    v_lshlrev_b32 v238, 16, v77
    v_mfma_f32_16x16x32_bf16 v[168:171], a[252:255], a[192:195], v[168:171]
    s_xor_b32 s55, s49, s48
    s_xor_b32 s55, s55, 1
    s_lshl2_add_u32 s55, s55, s70
    s_lshl_b32 s55, s55, 11
    v_add_u32 v41, s55, v41
    v_mfma_f32_16x16x32_bf16 v[184:187], a[252:255], a[196:199], v[184:187]
    s_add_u32 m0, s51, 131072
    v_and_b32 v239, 0xffff0000, v77
    v_mul_f32 v236, v236, v64
    v_mul_f32 v237, v237, v65
    v_mfma_f32_16x16x32_bf16 v[200:203], a[252:255], a[200:203], v[200:203]
    buffer_load_dwordx4 v30, s[28:31], s62 offen lds
    v_mfma_f32_16x16x32_bf16 v[216:219], a[252:255], a[204:207], v[216:219]
    v_mul_f32 v238, v238, v66
    v_mul_f32 v239, v239, v67
    s_waitcnt lgkmcnt(4)
    v_mfma_f32_16x16x32_bf16 v[164:167], v[48:51], a[192:195], v[164:167]
    ds_read_b64_tr_b16 a[248:249], v4 offset:4096
    v_cvt_pk_bf16_f32 v76, v236, v237
    v_cvt_pk_bf16_f32 v77, v238, v239
    v_mfma_f32_16x16x32_bf16 v[180:183], v[48:51], a[196:199], v[180:183]
    ds_read_b64_tr_b16 a[250:251], v4 offset:4608
    v_lshlrev_b32 v236, 16, v76
    v_and_b32 v237, 0xffff0000, v76
    v_mfma_f32_16x16x32_bf16 v[196:199], v[48:51], a[200:203], v[196:199]
    ds_read_b64_tr_b16 a[252:253], v4 offset:12288
    v_lshlrev_b32 v238, 16, v77
    v_and_b32 v239, 0xffff0000, v77
    v_mfma_f32_16x16x32_bf16 v[212:215], v[48:51], a[204:207], v[212:215]
    ds_read_b64_tr_b16 a[254:255], v4 offset:12800
    v_mul_f32 v236, v236, v12
    v_mul_f32 v237, v237, v12
    v_mfma_f32_16x16x32_bf16 v[172:175], v[52:55], a[192:195], v[172:175]
    buffer_load_dwordx4 v31, s[28:31], s62 offen offset:1024 lds
    v_mfma_f32_16x16x32_bf16 v[188:191], v[52:55], a[196:199], v[188:191]
    v_add_u32 v40, s50, v1
    v_mul_f32 v238, v238, v12
    v_mul_f32 v239, v239, v12
    v_mfma_f32_16x16x32_bf16 v[204:207], v[52:55], a[200:203], v[204:207]
    s_waitcnt vmcnt(5)
    v_cmp_eq_u32 vcc, 1, v38
    s_nop 0
    s_cmp_eq_u32 vcc_lo, s95
    s_cbranch_scc0 L_slow3
L_ok3:
    v_mfma_f32_16x16x32_bf16 v[220:223], v[52:55], a[204:207], v[220:223]
    s_barrier
    s_waitcnt lgkmcnt(4)
    v_mfma_f32_16x16x32_bf16 v[160:163], v[56:59], a[208:211], v[160:163]
    buffer_store_dword v35, v2, s[32:35], s80 offen offset:4 sc1
    s_add_u32 s80, s80, 32768
    buffer_load_dwordx4 a[144:147], v5, s[32:35], s64 offen sc1
    v_mfma_f32_16x16x32_bf16 v[168:171], v[60:63], a[208:211], v[168:171]
    s_waitcnt lgkmcnt(2)
    v_mfma_f32_16x16x32_bf16 v[164:167], a[248:251], a[208:211], v[164:167]
    buffer_load_dwordx4 a[148:151], v5, s[32:35], s65 offen sc1
    s_waitcnt lgkmcnt(0)
    v_mfma_f32_16x16x32_bf16 v[172:175], a[252:255], a[208:211], v[172:175]
    v_mfma_f32_16x16x32_bf16 v[176:179], v[56:59], a[212:215], v[176:179]
    buffer_load_dwordx4 a[152:155], v5, s[32:35], s66 offen sc1
    v_mfma_f32_16x16x32_bf16 v[184:187], v[60:63], a[212:215], v[184:187]
    v_mfma_f32_16x16x32_bf16 v[180:183], a[248:251], a[212:215], v[180:183]
    buffer_load_dwordx4 a[156:159], v5, s[32:35], s67 offen sc1
    v_mfma_f32_16x16x32_bf16 v[188:191], a[252:255], a[212:215], v[188:191]
    v_mul_f32 v160, v18, v160
    v_mul_f32 v161, v18, v161
    v_mul_f32 v162, v18, v162
    v_mul_f32 v163, v18, v163
    v_mul_f32 v164, v18, v164
    v_mfma_f32_16x16x32_bf16 v[192:195], v[56:59], a[216:219], v[192:195]
    buffer_load_dwordx4 a[160:163], v5, s[32:35], s68 offen sc1
    v_mfma_f32_16x16x32_bf16 v[200:203], v[60:63], a[216:219], v[200:203]
    v_mul_f32 v165, v18, v165
    v_mul_f32 v166, v18, v166
    v_mul_f32 v167, v18, v167
    v_mul_f32 v160, v160, v168
    v_mul_f32 v161, v161, v169
    v_mfma_f32_16x16x32_bf16 v[196:199], a[248:251], a[216:219], v[196:199]
    buffer_load_dwordx4 a[164:167], v5, s[32:35], s69 offen sc1
    v_mfma_f32_16x16x32_bf16 v[204:207], a[252:255], a[216:219], v[204:207]
    v_mul_f32 v162, v162, v170
    v_mul_f32 v163, v163, v171
    v_mul_f32 v164, v164, v172
    v_mul_f32 v165, v165, v173
    v_mul_f32 v166, v166, v174
    v_mfma_f32_16x16x32_bf16 v[208:211], v[56:59], a[220:223], v[208:211]
    buffer_load_dwordx4 a[168:171], v6, s[32:35], s64 offen sc1
    v_mfma_f32_16x16x32_bf16 v[216:219], v[60:63], a[220:223], v[216:219]
    v_mul_f32 v167, v167, v175
    v_cvt_pk_bf16_f32 v168, v160, v161
    v_cvt_pk_bf16_f32 v169, v162, v163
    v_cvt_pk_bf16_f32 v170, v164, v165
    v_cvt_pk_bf16_f32 v171, v166, v167
    v_mfma_f32_16x16x32_bf16 v[212:215], a[248:251], a[220:223], v[212:215]
    buffer_load_dwordx4 a[172:175], v6, s[32:35], s65 offen sc1
    v_mfma_f32_16x16x32_bf16 v[220:223], a[252:255], a[220:223], v[220:223]
    buffer_store_dwordx4 v[168:171], v7, s[32:35], s77 offen offset:1024 sc1
    ds_write_b128 v41, v[168:171] offset:32768
    v_pk_mul_f32 v[176:177], v[18:19], v[176:177] op_sel:[1,0]
    v_pk_mul_f32 v[178:179], v[18:19], v[178:179] op_sel:[1,0]
    v_pk_mul_f32 v[180:181], v[18:19], v[180:181] op_sel:[1,0]
    v_pk_mul_f32 v[182:183], v[18:19], v[182:183] op_sel:[1,0]
    v_pk_mul_f32 v[176:177], v[176:177], v[184:185]
    v_pk_mul_f32 v[178:179], v[178:179], v[186:187]
    v_pk_mul_f32 v[180:181], v[180:181], v[188:189]
    v_pk_mul_f32 v[182:183], v[182:183], v[190:191]
    v_cvt_pk_bf16_f32 v184, v176, v177
    v_cvt_pk_bf16_f32 v185, v178, v179
    v_cvt_pk_bf16_f32 v186, v180, v181
    v_cvt_pk_bf16_f32 v187, v182, v183
    buffer_store_dwordx4 v[184:187], v7, s[32:35], s77 offen offset:1280 sc1
    ds_write_b128 v41, v[184:187] offset:33024
    v_pk_mul_f32 v[192:193], v[14:15], v[192:193] op_sel_hi:[0,1]
    v_pk_mul_f32 v[194:195], v[14:15], v[194:195] op_sel_hi:[0,1]
    v_pk_mul_f32 v[196:197], v[14:15], v[196:197] op_sel_hi:[0,1]
    v_pk_mul_f32 v[198:199], v[14:15], v[198:199] op_sel_hi:[0,1]
    v_pk_mul_f32 v[192:193], v[192:193], v[200:201]
    v_pk_mul_f32 v[194:195], v[194:195], v[202:203]
    v_pk_mul_f32 v[196:197], v[196:197], v[204:205]
    v_pk_mul_f32 v[198:199], v[198:199], v[206:207]
    v_cvt_pk_bf16_f32 v200, v192, v193
    v_cvt_pk_bf16_f32 v201, v194, v195
    v_cvt_pk_bf16_f32 v202, v196, v197
    v_cvt_pk_bf16_f32 v203, v198, v199
    buffer_store_dwordx4 v[200:203], v7, s[32:35], s78 offen offset:1024 sc1
    ds_write_b128 v41, v[200:203] offset:36864
    v_pk_mul_f32 v[208:209], v[14:15], v[208:209] op_sel:[1,0]
    v_pk_mul_f32 v[210:211], v[14:15], v[210:211] op_sel:[1,0]
    v_pk_mul_f32 v[212:213], v[14:15], v[212:213] op_sel:[1,0]
    v_pk_mul_f32 v[214:215], v[14:15], v[214:215] op_sel:[1,0]
    v_pk_mul_f32 v[208:209], v[208:209], v[216:217]
    v_pk_mul_f32 v[210:211], v[210:211], v[218:219]
    v_pk_mul_f32 v[212:213], v[212:213], v[220:221]
    v_pk_mul_f32 v[214:215], v[214:215], v[222:223]
    v_cvt_pk_bf16_f32 v216, v208, v209
    v_cvt_pk_bf16_f32 v217, v210, v211
    v_cvt_pk_bf16_f32 v218, v212, v213
    v_cvt_pk_bf16_f32 v219, v214, v215
    buffer_store_dwordx4 v[216:219], v7, s[32:35], s78 offen offset:1280 sc1
    ds_write_b128 v41, v[216:219] offset:37120
    v_add_u32 v32, 0x10000, v32
    ds_read_b64_tr_b16 a[72:73], v32 offset:16384
    ds_read_b64_tr_b16 a[74:75], v32 offset:17408
    v_add_u32 v33, 0x10000, v33
    ds_read_b64_tr_b16 a[76:77], v33 offset:16384
    ds_read_b64_tr_b16 a[78:79], v33 offset:17408
    v_add_u32 v32, 0xffff8000, v32
    ds_read_b64_tr_b16 a[96:97], v32 offset:0
    ds_read_b64_tr_b16 a[98:99], v32 offset:1024
    v_add_u32 v33, 0xffff8000, v33
    ds_read_b64_tr_b16 a[100:101], v33 offset:0
    ds_read_b64_tr_b16 a[102:103], v33 offset:1024
    s_waitcnt vmcnt(15)
    ds_read_b64_tr_b16 a[120:121], v32 offset:16384
    ds_read_b64_tr_b16 a[122:123], v32 offset:17408
    ds_read_b64_tr_b16 a[124:125], v33 offset:16384
    ds_read_b64_tr_b16 a[126:127], v33 offset:17408
    buffer_load_dwordx4 a[176:179], v6, s[32:35], s66 offen sc1
    buffer_load_dwordx4 a[180:183], v6, s[32:35], s67 offen sc1
    buffer_load_dwordx4 a[184:187], v6, s[32:35], s68 offen sc1
    buffer_load_dwordx4 a[188:191], v6, s[32:35], s69 offen sc1
    s_waitcnt vmcnt(15)
    v_mfma_f32_32x32x16_bf16 v[64:79], a[0:3], a[144:147], 0
    ds_write_b128 v41, v[104:107] offset:16384
    v_mfma_f32_32x32x16_bf16 v[80:95], a[4:7], a[144:147], 0
    buffer_load_dwordx4 a[144:147], v8, s[32:35], s64 offen sc1
    ds_write_b128 v41, v[120:123] offset:16640
    s_waitcnt vmcnt(15)
    v_mfma_f32_32x32x16_bf16 v[64:79], a[24:27], a[148:151], v[64:79]
    v_mfma_f32_32x32x16_bf16 v[80:95], a[28:31], a[148:151], v[80:95]
    buffer_load_dwordx4 a[148:151], v8, s[32:35], s65 offen sc1
    ds_write_b128 v41, v[136:139] offset:20480
    s_waitcnt vmcnt(15)
    v_mfma_f32_32x32x16_bf16 v[64:79], a[48:51], a[152:155], v[64:79]
    ds_write_b128 v41, v[152:155] offset:20736
    v_mfma_f32_32x32x16_bf16 v[80:95], a[52:55], a[152:155], v[80:95]
    buffer_load_dwordx4 a[152:155], v8, s[32:35], s66 offen sc1
    s_waitcnt vmcnt(15) lgkmcnt(14)
    v_mfma_f32_32x32x16_bf16 v[64:79], a[72:75], a[156:159], v[64:79]
    s_waitcnt lgkmcnt(12)
    v_mfma_f32_32x32x16_bf16 v[80:95], a[76:79], a[156:159], v[80:95]
    buffer_load_dwordx4 a[156:159], v8, s[32:35], s67 offen sc1
    s_waitcnt vmcnt(15) lgkmcnt(10)
    v_mfma_f32_32x32x16_bf16 v[64:79], a[96:99], a[160:163], v[64:79]
    s_waitcnt lgkmcnt(0)
    s_barrier
    ds_read_b128 a[192:195], v40 offset:16384
    ds_read_b128 a[196:199], v40 offset:20480
    v_mfma_f32_32x32x16_bf16 v[80:95], a[100:103], a[160:163], v[80:95]
    buffer_load_dwordx4 a[160:163], v8, s[32:35], s68 offen sc1
    ds_read_b128 a[200:203], v40 offset:24576
    ds_read_b128 a[204:207], v40 offset:28672
    s_waitcnt vmcnt(15)
    v_mfma_f32_32x32x16_bf16 v[64:79], a[120:123], a[164:167], v[64:79]
    ds_read_b128 a[208:211], v40 offset:32768
    ds_read_b128 a[212:215], v40 offset:36864
    v_mfma_f32_32x32x16_bf16 v[80:95], a[124:127], a[164:167], v[80:95]
    buffer_load_dwordx4 a[164:167], v8, s[32:35], s69 offen sc1
    ds_read_b128 a[216:219], v40 offset:40960
    ds_read_b128 a[220:223], v40 offset:45056
    s_waitcnt lgkmcnt(7)
    v_mfma_f32_32x32x16_bf16 v[64:79], a[224:227], a[192:195], v[64:79]
    v_mfma_f32_32x32x16_bf16 v[80:95], a[228:231], a[192:195], v[80:95]
    s_waitcnt lgkmcnt(6)
    v_mfma_f32_32x32x16_bf16 v[96:111], a[224:227], a[196:199], 0
    v_mfma_f32_32x32x16_bf16 v[112:127], a[228:231], a[196:199], 0
    s_waitcnt lgkmcnt(5)
    v_mfma_f32_32x32x16_bf16 v[128:143], a[224:227], a[200:203], 0
    buffer_load_dword v38, v43, s[32:35], s82 offen offset:4 sc1
    v_mfma_f32_32x32x16_bf16 v[144:159], a[228:231], a[200:203], 0
    s_waitcnt lgkmcnt(4)
    v_mfma_f32_32x32x16_bf16 v[192:207], a[224:227], a[204:207], 0
    v_mfma_f32_32x32x16_bf16 v[208:223], a[228:231], a[204:207], 0
    s_waitcnt lgkmcnt(3)
    v_mfma_f32_32x32x16_bf16 v[64:79], a[232:235], a[208:211], v[64:79]
    v_mfma_f32_32x32x16_bf16 v[80:95], a[236:239], a[208:211], v[80:95]
    s_waitcnt lgkmcnt(2)
    v_mfma_f32_32x32x16_bf16 v[96:111], a[232:235], a[212:215], v[96:111]
    v_mfma_f32_32x32x16_bf16 v[112:127], a[236:239], a[212:215], v[112:127]
    s_waitcnt vmcnt(16)
    v_mfma_f32_32x32x16_bf16 v[96:111], a[0:3], a[168:171], v[96:111]
    s_waitcnt vmcnt(11) lgkmcnt(0)
    s_barrier
    buffer_store_dword v35, v2, s[32:35], s80 offen offset:4 sc1
    v_mfma_f32_32x32x16_bf16 v[112:127], a[4:7], a[168:171], v[112:127]
    buffer_load_dwordx4 a[168:171], v23, s[32:35], s64 offen sc1
    ds_read_b128 a[88:91], v34 offset:49152
    v_mfma_f32_32x32x16_bf16 v[96:111], a[24:27], a[172:175], v[96:111]
    ds_read_b128 a[92:95], v34 offset:53248
    v_xor_b32 v26, 32, v46
    v_mfma_f32_32x32x16_bf16 v[112:127], a[28:31], a[172:175], v[112:127]
    buffer_load_dwordx4 a[172:175], v23, s[32:35], s65 offen sc1
    s_waitcnt vmcnt(13)
    v_mfma_f32_32x32x16_bf16 v[96:111], a[48:51], a[176:179], v[96:111]
    ds_read_b128 a[112:115], v34 offset:40960
    v_mfma_f32_32x32x16_bf16 v[112:127], a[52:55], a[176:179], v[112:127]
    buffer_load_dwordx4 a[176:179], v23, s[32:35], s66 offen sc1
    ds_read_b128 a[116:119], v34 offset:45056
    s_waitcnt vmcnt(13)
    v_mfma_f32_32x32x16_bf16 v[96:111], a[72:75], a[180:183], v[96:111]
    ds_read_b128 a[136:139], v34 offset:32768
    v_mfma_f32_32x32x16_bf16 v[112:127], a[76:79], a[180:183], v[112:127]
    buffer_load_dwordx4 a[180:183], v23, s[32:35], s67 offen sc1
    s_waitcnt vmcnt(13)
    v_mfma_f32_32x32x16_bf16 v[96:111], a[96:99], a[184:187], v[96:111]
    ds_read_b128 a[140:143], v34 offset:36864
    v_xor_b32 v27, 64, v46
    v_mfma_f32_32x32x16_bf16 v[112:127], a[100:103], a[184:187], v[112:127]
    buffer_load_dwordx4 a[184:187], v23, s[32:35], s68 offen sc1
    ds_read_b64_tr_b16 a[80:81], v32 offset:51200
    s_waitcnt vmcnt(13)
    v_mfma_f32_32x32x16_bf16 v[96:111], a[120:123], a[188:191], v[96:111]
    ds_read_b64_tr_b16 a[82:83], v32 offset:52224
    v_mfma_f32_32x32x16_bf16 v[112:127], a[124:127], a[188:191], v[112:127]
    buffer_load_dwordx4 a[188:191], v23, s[32:35], s69 offen sc1
    ds_read_b64_tr_b16 a[84:85], v33 offset:51200
    s_waitcnt vmcnt(13)
    v_mfma_f32_32x32x16_bf16 v[128:143], a[0:3], a[144:147], v[128:143]
    s_waitcnt vmcnt(7)
    v_cmp_eq_u32 vcc, 1, v38
    s_nop 0
    s_cmp_eq_u32 vcc_lo, s100
    s_cbranch_scc0 L_slow4
L_ok4:
    s_barrier
    v_mfma_f32_32x32x16_bf16 v[144:159], a[4:7], a[144:147], v[144:159]
    buffer_load_dwordx4 a[144:147], v5, s[32:35], s63 offen offset:2048 sc1
    ds_read_b64_tr_b16 a[86:87], v33 offset:52224
    v_mfma_f32_32x32x16_bf16 v[128:143], a[24:27], a[148:151], v[128:143]
    ds_read_b64_tr_b16 a[104:105], v32 offset:2048
    v_xor_b32 v28, 96, v46
    v_mfma_f32_32x32x16_bf16 v[144:159], a[28:31], a[148:151], v[144:159]
    buffer_load_dwordx4 a[148:151], v5, s[32:35], s64 offen offset:2048 sc1
    ds_read_b64_tr_b16 a[106:107], v32 offset:3072
    v_mfma_f32_32x32x16_bf16 v[128:143], a[48:51], a[152:155], v[128:143]
    ds_read_b64_tr_b16 a[108:109], v33 offset:2048
    v_lshlrev_b32 v29, 1, v248
    v_mfma_f32_32x32x16_bf16 v[144:159], a[52:55], a[152:155], v[144:159]
    buffer_load_dwordx4 a[152:155], v5, s[32:35], s65 offen offset:2048 sc1
    v_mfma_f32_32x32x16_bf16 v[128:143], a[72:75], a[156:159], v[128:143]
    ds_read_b64_tr_b16 a[110:111], v33 offset:3072
    v_mfma_f32_32x32x16_bf16 v[144:159], a[76:79], a[156:159], v[144:159]
    buffer_load_dwordx4 a[156:159], v5, s[32:35], s66 offen offset:2048 sc1
    ds_read_b64_tr_b16 a[128:129], v32 offset:18432
    v_mfma_f32_32x32x16_bf16 v[128:143], a[96:99], a[160:163], v[128:143]
    ds_read_b64_tr_b16 a[130:131], v32 offset:19456
    v_mfma_f32_32x32x16_bf16 v[144:159], a[100:103], a[160:163], v[144:159]
    buffer_load_dwordx4 a[160:163], v5, s[32:35], s67 offen offset:2048 sc1
    v_mfma_f32_32x32x16_bf16 v[128:143], a[120:123], a[164:167], v[128:143]
    ds_read_b64_tr_b16 a[132:133], v33 offset:18432
    v_mfma_f32_32x32x16_bf16 v[144:159], a[124:127], a[164:167], v[144:159]
    buffer_load_dwordx4 a[164:167], v5, s[32:35], s68 offen offset:2048 sc1
    ds_read_b64_tr_b16 a[134:135], v33 offset:19456
    s_waitcnt vmcnt(11)
    v_mfma_f32_32x32x16_bf16 v[192:207], a[0:3], a[168:171], v[192:207]
    v_mfma_f32_32x32x16_bf16 v[208:223], a[4:7], a[168:171], v[208:223]
    buffer_load_dwordx4 a[168:171], v5, s[32:35], s69 offen offset:2048 sc1
    s_waitcnt vmcnt(11)
    v_mfma_f32_32x32x16_bf16 v[192:207], a[24:27], a[172:175], v[192:207]
    s_add_u32 s81, s81, 65536
    buffer_load_dword v38, v42, s[32:35], s81 offen offset:4 sc1
    v_mfma_f32_32x32x16_bf16 v[208:223], a[28:31], a[172:175], v[208:223]
    buffer_load_dwordx4 a[172:175], v6, s[32:35], s63 offen offset:2048 sc1
    s_waitcnt vmcnt(12)
    v_mfma_f32_32x32x16_bf16 v[192:207], a[48:51], a[176:179], v[192:207]
    v_mfma_f32_32x32x16_bf16 v[208:223], a[52:55], a[176:179], v[208:223]
    buffer_load_dwordx4 a[176:179], v6, s[32:35], s64 offen offset:2048 sc1
    s_waitcnt vmcnt(12)
    v_mfma_f32_32x32x16_bf16 v[192:207], a[72:75], a[180:183], v[192:207]
    v_mfma_f32_32x32x16_bf16 v[208:223], a[76:79], a[180:183], v[208:223]
    buffer_load_dwordx4 a[180:183], v6, s[32:35], s65 offen offset:2048 sc1
    s_waitcnt vmcnt(12)
    v_mfma_f32_32x32x16_bf16 v[192:207], a[96:99], a[184:187], v[192:207]
    v_mfma_f32_32x32x16_bf16 v[208:223], a[100:103], a[184:187], v[208:223]
    buffer_load_dwordx4 a[184:187], v6, s[32:35], s66 offen offset:2048 sc1
    s_waitcnt vmcnt(12)
    v_mfma_f32_32x32x16_bf16 v[192:207], a[120:123], a[188:191], v[192:207]
    v_mfma_f32_32x32x16_bf16 v[208:223], a[124:127], a[188:191], v[208:223]
    buffer_load_dwordx4 a[188:191], v6, s[32:35], s67 offen offset:2048 sc1
    s_waitcnt vmcnt(12)
    v_mfma_f32_32x32x16_bf16 v[64:79], a[240:243], a[144:147], v[64:79]
    v_mfma_f32_32x32x16_bf16 v[80:95], a[244:247], a[144:147], v[80:95]
    buffer_load_dwordx4 a[144:147], v6, s[32:35], s68 offen offset:2048 sc1
    s_waitcnt vmcnt(12)
    v_mfma_f32_32x32x16_bf16 v[64:79], a[16:19], a[148:151], v[64:79]
    v_mfma_f32_32x32x16_bf16 v[80:95], a[20:23], a[148:151], v[80:95]
    buffer_load_dwordx4 a[148:151], v6, s[32:35], s69 offen offset:2048 sc1
    s_waitcnt vmcnt(12)
    v_mfma_f32_32x32x16_bf16 v[64:79], a[40:43], a[152:155], v[64:79]
    v_mfma_f32_32x32x16_bf16 v[80:95], a[44:47], a[152:155], v[80:95]
    s_waitcnt vmcnt(11)
    v_mfma_f32_32x32x16_bf16 v[64:79], a[64:67], a[156:159], v[64:79]
    v_mfma_f32_32x32x16_bf16 v[80:95], a[68:71], a[156:159], v[80:95]
    s_waitcnt vmcnt(10) lgkmcnt(15)
    v_mfma_f32_32x32x16_bf16 v[64:79], a[88:91], a[160:163], v[64:79]
    v_mfma_f32_32x32x16_bf16 v[80:95], a[92:95], a[160:163], v[80:95]
    s_waitcnt vmcnt(9)
    v_mfma_f32_32x32x16_bf16 v[64:79], a[112:115], a[164:167], v[64:79]
    s_waitcnt vmcnt(7)
    v_cmp_eq_u32 vcc, 1, v38
    s_nop 0
    s_cmp_eq_u32 vcc_lo, s95
    s_cbranch_scc0 L_slow5
L_ok5:
    s_barrier
    buffer_load_dwordx4 a[152:155], v5, s[32:35], s64 offen offset:1024 sc1
    s_waitcnt lgkmcnt(14)
    v_mfma_f32_32x32x16_bf16 v[80:95], a[116:119], a[164:167], v[80:95]
    buffer_load_dwordx4 a[156:159], v5, s[32:35], s65 offen offset:1024 sc1
    s_waitcnt lgkmcnt(13)
    v_mfma_f32_32x32x16_bf16 v[64:79], a[136:139], a[168:171], v[64:79]
    buffer_load_dwordx4 a[160:163], v5, s[32:35], s66 offen offset:1024 sc1
    s_waitcnt lgkmcnt(12)
    v_mfma_f32_32x32x16_bf16 v[80:95], a[140:143], a[168:171], v[80:95]
    buffer_load_dwordx4 a[164:167], v5, s[32:35], s67 offen offset:1024 sc1
    s_waitcnt vmcnt(10)
    v_mfma_f32_32x32x16_bf16 v[96:111], a[240:243], a[172:175], v[96:111]
    buffer_load_dwordx4 a[168:171], v5, s[32:35], s68 offen offset:1024 sc1
    v_mfma_f32_32x32x16_bf16 v[112:127], a[244:247], a[172:175], v[112:127]
    buffer_load_dwordx4 a[172:175], v5, s[32:35], s69 offen offset:1024 sc1
    s_waitcnt vmcnt(11)
    v_mfma_f32_32x32x16_bf16 v[96:111], a[16:19], a[176:179], v[96:111]
    v_mfma_f32_32x32x16_bf16 v[112:127], a[20:23], a[176:179], v[112:127]
    buffer_load_dwordx4 a[176:179], v6, s[32:35], s64 offen offset:1024 sc1
    s_waitcnt vmcnt(11)
    v_mfma_f32_32x32x16_bf16 v[96:111], a[40:43], a[180:183], v[96:111]
    v_mfma_f32_32x32x16_bf16 v[112:127], a[44:47], a[180:183], v[112:127]
    buffer_load_dwordx4 a[180:183], v6, s[32:35], s65 offen offset:1024 sc1
    s_waitcnt vmcnt(11)
    v_mfma_f32_32x32x16_bf16 v[96:111], a[64:67], a[184:187], v[96:111]
    v_mfma_f32_32x32x16_bf16 v[112:127], a[68:71], a[184:187], v[112:127]
    buffer_load_dwordx4 a[184:187], v6, s[32:35], s66 offen offset:1024 sc1
    s_waitcnt vmcnt(11)
    v_mfma_f32_32x32x16_bf16 v[96:111], a[88:91], a[188:191], v[96:111]
    v_mfma_f32_32x32x16_bf16 v[112:127], a[92:95], a[188:191], v[112:127]
    buffer_load_dwordx4 a[188:191], v6, s[32:35], s67 offen offset:1024 sc1
    s_waitcnt vmcnt(11)
    v_mfma_f32_32x32x16_bf16 v[96:111], a[112:115], a[144:147], v[96:111]
    v_mfma_f32_32x32x16_bf16 v[112:127], a[116:119], a[144:147], v[112:127]
    buffer_load_dwordx4 a[144:147], v6, s[32:35], s68 offen offset:1024 sc1
    s_waitcnt vmcnt(11)
    v_mfma_f32_32x32x16_bf16 v[96:111], a[136:139], a[148:151], v[96:111]
    v_mfma_f32_32x32x16_bf16 v[112:127], a[140:143], a[148:151], v[112:127]
    buffer_load_dwordx4 a[148:151], v6, s[32:35], s69 offen offset:1024 sc1
    s_waitcnt vmcnt(11)
    v_mfma_f32_32x32x16_bf16 v[64:79], a[8:11], a[152:155], v[64:79]
    v_mfma_f32_32x32x16_bf16 v[80:95], a[12:15], a[152:155], v[80:95]
    buffer_load_dwordx4 a[152:155], v8, s[32:35], s63 offen offset:2048 sc1
    s_waitcnt vmcnt(11)
    v_mfma_f32_32x32x16_bf16 v[64:79], a[32:35], a[156:159], v[64:79]
    v_mfma_f32_32x32x16_bf16 v[80:95], a[36:39], a[156:159], v[80:95]
    buffer_load_dwordx4 a[156:159], v8, s[32:35], s64 offen offset:2048 sc1
    s_waitcnt vmcnt(11)
    v_mfma_f32_32x32x16_bf16 v[64:79], a[56:59], a[160:163], v[64:79]
    v_mfma_f32_32x32x16_bf16 v[80:95], a[60:63], a[160:163], v[80:95]
    buffer_load_dwordx4 a[160:163], v8, s[32:35], s65 offen offset:2048 sc1
    s_waitcnt vmcnt(11) lgkmcnt(10)
    v_mfma_f32_32x32x16_bf16 v[64:79], a[80:83], a[164:167], v[64:79]
    s_waitcnt lgkmcnt(8)
    v_mfma_f32_32x32x16_bf16 v[80:95], a[84:87], a[164:167], v[80:95]
    buffer_load_dwordx4 a[164:167], v8, s[32:35], s66 offen offset:2048 sc1
    s_waitcnt vmcnt(11) lgkmcnt(6)
    v_mfma_f32_32x32x16_bf16 v[64:79], a[104:107], a[168:171], v[64:79]
    s_waitcnt lgkmcnt(4)
    v_mfma_f32_32x32x16_bf16 v[80:95], a[108:111], a[168:171], v[80:95]
    buffer_load_dwordx4 a[168:171], v8, s[32:35], s67 offen offset:2048 sc1
    s_waitcnt vmcnt(11) lgkmcnt(2)
    v_mfma_f32_32x32x16_bf16 v[64:79], a[128:131], a[172:175], v[64:79]
    s_waitcnt lgkmcnt(0)
    v_mfma_f32_32x32x16_bf16 v[80:95], a[132:135], a[172:175], v[80:95]
    buffer_load_dwordx4 a[172:175], v8, s[32:35], s68 offen offset:2048 sc1
    s_waitcnt vmcnt(11)
    v_mfma_f32_32x32x16_bf16 v[96:111], a[8:11], a[176:179], v[96:111]
    v_mfma_f32_32x32x16_bf16 v[112:127], a[12:15], a[176:179], v[112:127]
    buffer_load_dwordx4 a[176:179], v8, s[32:35], s69 offen offset:2048 sc1
    s_nop 4
    ds_write_b128 v46, v[64:67] offset:0
    s_waitcnt vmcnt(11)
    v_mfma_f32_32x32x16_bf16 v[96:111], a[32:35], a[180:183], v[96:111]
    ds_write_b128 v26, v[68:71] offset:0
    v_mfma_f32_32x32x16_bf16 v[112:127], a[36:39], a[180:183], v[112:127]
    buffer_load_dwordx4 a[180:183], v8, s[32:35], s64 offen offset:1024 sc1
    ds_write_b128 v27, v[72:75] offset:0
    s_waitcnt vmcnt(11)
    v_mfma_f32_32x32x16_bf16 v[96:111], a[56:59], a[184:187], v[96:111]
    ds_write_b128 v28, v[76:79] offset:0
    v_mfma_f32_32x32x16_bf16 v[112:127], a[60:63], a[184:187], v[112:127]
    buffer_load_dwordx4 a[184:187], v8, s[32:35], s65 offen offset:1024 sc1
    ds_write_b128 v46, v[80:83] offset:128
    s_waitcnt vmcnt(11)
    v_mfma_f32_32x32x16_bf16 v[96:111], a[80:83], a[188:191], v[96:111]
    ds_write_b128 v26, v[84:87] offset:128
    v_mfma_f32_32x32x16_bf16 v[112:127], a[84:87], a[188:191], v[112:127]
    buffer_load_dwordx4 a[188:191], v8, s[32:35], s66 offen offset:1024 sc1
    ds_write_b128 v27, v[88:91] offset:128
    s_waitcnt vmcnt(11)
    v_mfma_f32_32x32x16_bf16 v[96:111], a[104:107], a[144:147], v[96:111]
    ds_write_b128 v28, v[92:95] offset:128
    v_mfma_f32_32x32x16_bf16 v[112:127], a[108:111], a[144:147], v[112:127]
    buffer_load_dwordx4 a[144:147], v8, s[32:35], s67 offen offset:1024 sc1
    s_waitcnt lgkmcnt(0)
    s_barrier
    ds_read_b128 v[160:163], v47 offset:0
    ds_read_b128 v[164:167], v47 offset:8192
    s_waitcnt vmcnt(11)
    v_mfma_f32_32x32x16_bf16 v[96:111], a[128:131], a[148:151], v[96:111]
    ds_read_b128 v[168:171], v47 offset:16384
    ds_read_b128 v[172:175], v47 offset:24576
    v_mfma_f32_32x32x16_bf16 v[112:127], a[132:135], a[148:151], v[112:127]
    buffer_load_dwordx4 a[148:151], v8, s[32:35], s68 offen offset:1024 sc1
    ds_read_b128 v[176:179], v47 offset:1024
    ds_read_b128 v[180:183], v47 offset:9216
    v_mfma_f32_32x32x16_bf16 v[128:143], a[232:235], a[216:219], v[128:143]
    ds_read_b128 v[184:187], v47 offset:17408
    ds_read_b128 v[188:191], v47 offset:25600
    v_mfma_f32_32x32x16_bf16 v[144:159], a[236:239], a[216:219], v[144:159]
    s_nop 1
    ds_write_b128 v46, v[96:99] offset:32768
    s_waitcnt vmcnt(11)
    v_mfma_f32_32x32x16_bf16 v[128:143], a[240:243], a[152:155], v[128:143]
    ds_write_b128 v26, v[100:103] offset:32768
    s_waitcnt lgkmcnt(8)
    v_add_f32 v160, v160, v164
    v_add_f32 v161, v161, v165
    v_add_f32 v162, v162, v166
    v_add_f32 v163, v163, v167
    s_waitcnt lgkmcnt(6)
    v_add_f32 v168, v168, v172
    v_add_f32 v169, v169, v173
    v_add_f32 v170, v170, v174
    v_add_f32 v171, v171, v175
    v_add_f32 v160, v160, v168
    v_add_f32 v161, v161, v169
    v_mfma_f32_32x32x16_bf16 v[144:159], a[244:247], a[152:155], v[144:159]
    buffer_load_dwordx4 a[152:155], v8, s[32:35], s69 offen offset:1024 sc1
    ds_write_b128 v27, v[104:107] offset:32768
    v_add_f32 v162, v162, v170
    v_add_f32 v163, v163, v171
    v_cvt_pk_bf16_f32 v164, v160, v161
    v_cvt_pk_bf16_f32 v165, v162, v163
    v_min_u32 v164, -2, v164
    v_min_u32 v165, -2, v165
    s_waitcnt vmcnt(11)
    v_mfma_f32_32x32x16_bf16 v[128:143], a[16:19], a[156:159], v[128:143]
    ds_write_b128 v28, v[108:111] offset:32768
    s_waitcnt lgkmcnt(6)
    v_add_f32 v176, v176, v180
    v_add_f32 v177, v177, v181
    v_add_f32 v178, v178, v182
    v_add_f32 v179, v179, v183
    s_waitcnt lgkmcnt(4)
    v_add_f32 v184, v184, v188
    v_add_f32 v185, v185, v189
    v_add_f32 v186, v186, v190
    v_add_f32 v187, v187, v191
    v_add_f32 v176, v176, v184
    v_add_f32 v177, v177, v185
    v_mfma_f32_32x32x16_bf16 v[144:159], a[20:23], a[156:159], v[144:159]
    buffer_load_dwordx4 a[156:159], v23, s[32:35], s63 offen offset:2048 sc1
    ds_write_b128 v46, v[112:115] offset:32896
    v_add_f32 v178, v178, v186
    v_add_f32 v179, v179, v187
    v_cvt_pk_bf16_f32 v166, v176, v177
    v_cvt_pk_bf16_f32 v167, v178, v179
    v_min_u32 v166, -2, v166
    v_min_u32 v167, -2, v167
    buffer_store_dwordx4 v[164:167], v252, s[32:35], s83 offen sc1
    s_waitcnt vmcnt(12)
L_pg4:
    s_cbranch_execz L_back2
    v_mfma_f32_32x32x16_bf16 v[128:143], a[40:43], a[160:163], v[128:143]
    ds_write_b128 v26, v[116:119] offset:32896
    v_mfma_f32_32x32x16_bf16 v[144:159], a[44:47], a[160:163], v[144:159]
    buffer_load_dwordx4 a[160:163], v23, s[32:35], s64 offen offset:2048 sc1
    ds_write_b128 v27, v[120:123] offset:32896
    s_waitcnt vmcnt(12)
    v_mfma_f32_32x32x16_bf16 v[128:143], a[64:67], a[164:167], v[128:143]
    ds_write_b128 v28, v[124:127] offset:32896
    s_add_u32 s91, s84, 8192
    v_mfma_f32_32x32x16_bf16 v[144:159], a[68:71], a[164:167], v[144:159]
    buffer_load_dwordx4 a[164:167], v23, s[32:35], s65 offen offset:2048 sc1
    s_waitcnt lgkmcnt(0)
    s_barrier
    ds_read_b128 v[160:163], v47 offset:32768
    ds_read_b128 v[164:167], v47 offset:40960
    s_waitcnt vmcnt(12)
    v_mfma_f32_32x32x16_bf16 v[128:143], a[88:91], a[168:171], v[128:143]
    ds_read_b128 v[168:171], v47 offset:49152
    ds_read_b128 v[172:175], v47 offset:57344
    v_mfma_f32_32x32x16_bf16 v[144:159], a[92:95], a[168:171], v[144:159]
    buffer_load_dwordx4 a[168:171], v23, s[32:35], s66 offen offset:2048 sc1
    ds_read_b128 v[176:179], v47 offset:33792
    ds_read_b128 v[180:183], v47 offset:41984
    s_waitcnt vmcnt(12)
    v_mfma_f32_32x32x16_bf16 v[128:143], a[112:115], a[172:175], v[128:143]
    ds_read_b128 v[184:187], v47 offset:50176
    ds_read_b128 v[188:191], v47 offset:58368
    v_mfma_f32_32x32x16_bf16 v[144:159], a[116:119], a[172:175], v[144:159]
    buffer_load_dwordx4 a[172:175], v23, s[32:35], s67 offen offset:2048 sc1
    s_waitcnt vmcnt(12)
    v_mfma_f32_32x32x16_bf16 v[128:143], a[136:139], a[176:179], v[128:143]
    s_waitcnt lgkmcnt(6)
    v_add_f32 v160, v160, v164
    v_add_f32 v161, v161, v165
    v_add_f32 v162, v162, v166
    v_add_f32 v163, v163, v167
    s_waitcnt lgkmcnt(4)
    v_add_f32 v168, v168, v172
    v_add_f32 v169, v169, v173
    v_add_f32 v170, v170, v174
    v_add_f32 v171, v171, v175
    v_add_f32 v160, v160, v168
    v_add_f32 v161, v161, v169
    v_mfma_f32_32x32x16_bf16 v[144:159], a[140:143], a[176:179], v[144:159]
    buffer_load_dwordx4 a[176:179], v23, s[32:35], s68 offen offset:2048 sc1
    v_add_f32 v162, v162, v170
    v_add_f32 v163, v163, v171
    v_cvt_pk_bf16_f32 v164, v160, v161
    v_cvt_pk_bf16_f32 v165, v162, v163
    v_min_u32 v164, -2, v164
    v_min_u32 v165, -2, v165
    s_waitcnt vmcnt(12)
    v_mfma_f32_32x32x16_bf16 v[128:143], a[8:11], a[180:183], v[128:143]
    s_waitcnt lgkmcnt(2)
    v_add_f32 v176, v176, v180
    v_add_f32 v177, v177, v181
    v_add_f32 v178, v178, v182
    v_add_f32 v179, v179, v183
    s_waitcnt lgkmcnt(0)
    v_add_f32 v184, v184, v188
    v_add_f32 v185, v185, v189
    v_add_f32 v186, v186, v190
    v_add_f32 v187, v187, v191
    v_add_f32 v176, v176, v184
    v_add_f32 v177, v177, v185
    v_mfma_f32_32x32x16_bf16 v[144:159], a[12:15], a[180:183], v[144:159]
    buffer_load_dwordx4 a[180:183], v23, s[32:35], s69 offen offset:2048 sc1
    v_add_f32 v178, v178, v186
    v_add_f32 v179, v179, v187
    v_cvt_pk_bf16_f32 v166, v176, v177
    v_cvt_pk_bf16_f32 v167, v178, v179
    v_min_u32 v166, -2, v166
    v_min_u32 v167, -2, v167
    buffer_store_dwordx4 v[164:167], v252, s[32:35], s83 offen offset:1024 sc1
    s_waitcnt vmcnt(13)
    v_mfma_f32_32x32x16_bf16 v[128:143], a[32:35], a[184:187], v[128:143]
    v_mfma_f32_32x32x16_bf16 v[144:159], a[36:39], a[184:187], v[144:159]
    buffer_load_dwordx4 a[184:187], v23, s[32:35], s64 offen offset:1024 sc1
    s_waitcnt vmcnt(13)
    v_mfma_f32_32x32x16_bf16 v[128:143], a[56:59], a[188:191], v[128:143]
    v_mfma_f32_32x32x16_bf16 v[144:159], a[60:63], a[188:191], v[144:159]
    buffer_load_dwordx4 a[188:191], v23, s[32:35], s65 offen offset:1024 sc1
    s_waitcnt vmcnt(13)
    v_mfma_f32_32x32x16_bf16 v[128:143], a[80:83], a[144:147], v[128:143]
    v_mfma_f32_32x32x16_bf16 v[144:159], a[84:87], a[144:147], v[144:159]
    buffer_load_dwordx4 a[144:147], v23, s[32:35], s66 offen offset:1024 sc1
    s_waitcnt vmcnt(13)
    v_mfma_f32_32x32x16_bf16 v[128:143], a[104:107], a[148:151], v[128:143]
    v_mfma_f32_32x32x16_bf16 v[144:159], a[108:111], a[148:151], v[144:159]
    buffer_load_dwordx4 a[148:151], v23, s[32:35], s67 offen offset:1024 sc1
    s_waitcnt vmcnt(13)
    v_mfma_f32_32x32x16_bf16 v[128:143], a[128:131], a[152:155], v[128:143]
    v_mfma_f32_32x32x16_bf16 v[144:159], a[132:135], a[152:155], v[144:159]
    buffer_load_dwordx4 a[152:155], v23, s[32:35], s68 offen offset:1024 sc1
    v_mfma_f32_32x32x16_bf16 v[192:207], a[232:235], a[220:223], v[192:207]
    v_mfma_f32_32x32x16_bf16 v[208:223], a[236:239], a[220:223], v[208:223]
    s_nop 7
    ds_write_b128 v46, v[128:131] offset:0
    s_waitcnt vmcnt(13)
    v_mfma_f32_32x32x16_bf16 v[192:207], a[240:243], a[156:159], v[192:207]
    ds_write_b128 v26, v[132:135] offset:0
    v_mfma_f32_32x32x16_bf16 v[208:223], a[244:247], a[156:159], v[208:223]
    buffer_load_dwordx4 a[156:159], v23, s[32:35], s69 offen offset:1024 sc1
    ds_write_b128 v27, v[136:139] offset:0
    s_waitcnt vmcnt(12)
    v_mfma_f32_32x32x16_bf16 v[192:207], a[16:19], a[160:163], v[192:207]
    v_mfma_f32_32x32x16_bf16 v[208:223], a[20:23], a[160:163], v[208:223]
    ds_write_b128 v28, v[140:143] offset:0
    s_waitcnt vmcnt(11)
    v_mfma_f32_32x32x16_bf16 v[192:207], a[40:43], a[164:167], v[192:207]
    ds_write_b128 v46, v[144:147] offset:128
    v_mfma_f32_32x32x16_bf16 v[208:223], a[44:47], a[164:167], v[208:223]
    s_waitcnt vmcnt(10)
    v_mfma_f32_32x32x16_bf16 v[192:207], a[64:67], a[168:171], v[192:207]
    ds_write_b128 v26, v[148:151] offset:128
    v_mfma_f32_32x32x16_bf16 v[208:223], a[68:71], a[168:171], v[208:223]
    ds_write_b128 v27, v[152:155] offset:128
    s_waitcnt vmcnt(9)
    v_mfma_f32_32x32x16_bf16 v[192:207], a[88:91], a[172:175], v[192:207]
    v_mfma_f32_32x32x16_bf16 v[208:223], a[92:95], a[172:175], v[208:223]
    ds_write_b128 v28, v[156:159] offset:128
    s_waitcnt vmcnt(8)
    v_mfma_f32_32x32x16_bf16 v[192:207], a[112:115], a[176:179], v[192:207]
    v_mfma_f32_32x32x16_bf16 v[208:223], a[116:119], a[176:179], v[208:223]
    s_waitcnt vmcnt(7)
    v_mfma_f32_32x32x16_bf16 v[192:207], a[136:139], a[180:183], v[192:207]
    v_mfma_f32_32x32x16_bf16 v[208:223], a[140:143], a[180:183], v[208:223]
    s_waitcnt lgkmcnt(0)
    s_barrier
    ds_read_b128 v[160:163], v47 offset:0
    ds_read_b128 v[164:167], v47 offset:8192
    s_waitcnt vmcnt(5)
    v_mfma_f32_32x32x16_bf16 v[192:207], a[8:11], a[184:187], v[192:207]
    ds_read_b128 v[168:171], v47 offset:16384
    ds_read_b128 v[172:175], v47 offset:24576
    s_waitcnt vmcnt(4)
    v_mfma_f32_32x32x16_bf16 v[192:207], a[32:35], a[188:191], v[192:207]
    ds_read_b128 v[176:179], v47 offset:1024
    ds_read_b128 v[180:183], v47 offset:9216
    s_waitcnt vmcnt(3)
    v_mfma_f32_32x32x16_bf16 v[192:207], a[56:59], a[144:147], v[192:207]
    ds_read_b128 v[184:187], v47 offset:17408
    ds_read_b128 v[188:191], v47 offset:25600
    s_waitcnt vmcnt(2)
    v_mfma_f32_32x32x16_bf16 v[192:207], a[80:83], a[148:151], v[192:207]
    s_waitcnt vmcnt(1)
    v_mfma_f32_32x32x16_bf16 v[192:207], a[104:107], a[152:155], v[192:207]
    buffer_load_dwordx4 v[52:55], v252, s[32:35], s84 offen sc1
    s_waitcnt lgkmcnt(6)
    v_add_f32 v160, v160, v164
    v_add_f32 v161, v161, v165
    v_add_f32 v162, v162, v166
    v_add_f32 v163, v163, v167
    s_waitcnt lgkmcnt(4)
    v_add_f32 v168, v168, v172
    s_waitcnt vmcnt(1)
    v_mfma_f32_32x32x16_bf16 v[192:207], a[128:131], a[156:159], v[192:207]
    v_add_f32 v169, v169, v173
    v_add_f32 v170, v170, v174
    v_add_f32 v171, v171, v175
    v_add_f32 v160, v160, v168
    v_add_f32 v161, v161, v169
    v_add_f32 v162, v162, v170
    v_mfma_f32_32x32x16_bf16 v[208:223], a[12:15], a[184:187], v[208:223]
    v_add_f32 v163, v163, v171
    v_add_f32 v224, v160, v224
    v_add_f32 v225, v161, v225
    v_add_f32 v226, v162, v226
    v_add_f32 v227, v163, v227
    v_mfma_f32_32x32x16_bf16 v[208:223], a[36:39], a[188:191], v[208:223]
    ds_write_b128 v46, v[192:195] offset:32768
    s_waitcnt lgkmcnt(3)
    v_add_f32 v176, v176, v180
    v_add_f32 v177, v177, v181
    v_add_f32 v178, v178, v182
    v_add_f32 v179, v179, v183
    s_waitcnt lgkmcnt(1)
    v_add_f32 v184, v184, v188
    v_mfma_f32_32x32x16_bf16 v[208:223], a[60:63], a[144:147], v[208:223]
    ds_write_b128 v26, v[196:199] offset:32768
    v_add_f32 v185, v185, v189
    v_add_f32 v186, v186, v190
    v_add_f32 v187, v187, v191
    v_add_f32 v176, v176, v184
    v_add_f32 v177, v177, v185
    v_add_f32 v178, v178, v186
    v_mfma_f32_32x32x16_bf16 v[208:223], a[84:87], a[148:151], v[208:223]
    ds_write_b128 v27, v[200:203] offset:32768
    v_add_f32 v179, v179, v187
    v_add_f32 v228, v176, v228
    v_add_f32 v229, v177, v229
    v_add_f32 v230, v178, v230
    v_add_f32 v231, v179, v231
    v_mfma_f32_32x32x16_bf16 v[208:223], a[108:111], a[152:155], v[208:223]
    ds_write_b128 v28, v[204:207] offset:32768
    v_mfma_f32_32x32x16_bf16 v[208:223], a[132:135], a[156:159], v[208:223]
    buffer_load_dwordx4 v[60:63], v252, s[32:35], s84 offen offset:1024 sc1
    s_nop 10
    ds_write_b128 v46, v[208:211] offset:32896
    ds_write_b128 v26, v[212:215] offset:32896
    ds_write_b128 v27, v[216:219] offset:32896
    ds_write_b128 v28, v[220:223] offset:32896
    s_waitcnt vmcnt(1)
    v_max3_u32 v13, v52, v53, v54
    v_max_u32 v13, v13, v55
    v_cmp_eq_u32 vcc, -1, v13
    s_nop 0
    s_cmp_eq_u64 vcc, 0
    s_cbranch_scc0 L_slow6
L_ok6:
    v_lshlrev_b32 v48, 16, v52
    v_and_b32 v49, 0xffff0000, v52
    v_lshlrev_b32 v50, 16, v53
    v_and_b32 v51, 0xffff0000, v53
    v_lshlrev_b32 v52, 16, v54
    v_and_b32 v53, 0xffff0000, v54
    v_lshlrev_b32 v54, 16, v55
    v_and_b32 v55, 0xffff0000, v55
    v_add_f32 v224, v224, v48
    v_add_f32 v225, v225, v49
    v_add_f32 v226, v226, v50
    v_add_f32 v227, v227, v51
    s_mov_b32 s55, 0
    buffer_store_dwordx4 v[224:227], v29, s[36:39], s55 offen sc1
    v_add_f32 v228, v228, v52
    v_add_f32 v229, v229, v53
    v_add_f32 v230, v230, v54
    v_add_f32 v231, v231, v55
    s_mov_b32 s55, 7168
    buffer_store_dwordx4 v[228:231], v29, s[36:39], s55 offen sc1
    s_waitcnt lgkmcnt(0)
    s_barrier
    ds_read_b128 v[160:163], v47 offset:32768
    ds_read_b128 v[164:167], v47 offset:40960
    ds_read_b128 v[168:171], v47 offset:49152
    ds_read_b128 v[172:175], v47 offset:57344
    ds_read_b128 v[176:179], v47 offset:33792
    ds_read_b128 v[180:183], v47 offset:41984
    ds_read_b128 v[184:187], v47 offset:50176
    ds_read_b128 v[188:191], v47 offset:58368
    s_waitcnt lgkmcnt(7)
    v_pk_add_f32 v[232:233], v[232:233], v[160:161]
    v_pk_add_f32 v[234:235], v[234:235], v[162:163]
    s_waitcnt lgkmcnt(6)
    v_pk_add_f32 v[232:233], v[232:233], v[164:165]
    v_pk_add_f32 v[234:235], v[234:235], v[166:167]
    s_waitcnt lgkmcnt(5)
    v_pk_add_f32 v[232:233], v[232:233], v[168:169]
    v_pk_add_f32 v[234:235], v[234:235], v[170:171]
    s_waitcnt lgkmcnt(4)
    v_pk_add_f32 v[232:233], v[232:233], v[172:173]
    v_pk_add_f32 v[234:235], v[234:235], v[174:175]
    s_waitcnt lgkmcnt(3)
    v_pk_add_f32 v[236:237], v[236:237], v[176:177]
    v_pk_add_f32 v[238:239], v[238:239], v[178:179]
    s_waitcnt lgkmcnt(2)
    v_pk_add_f32 v[236:237], v[236:237], v[180:181]
    v_pk_add_f32 v[238:239], v[238:239], v[182:183]
    s_waitcnt lgkmcnt(1)
    v_pk_add_f32 v[236:237], v[236:237], v[184:185]
    v_pk_add_f32 v[238:239], v[238:239], v[186:187]
    s_waitcnt lgkmcnt(0)
    v_pk_add_f32 v[236:237], v[236:237], v[188:189]
    v_pk_add_f32 v[238:239], v[238:239], v[190:191]
    s_waitcnt vmcnt(2)
    v_max3_u32 v13, v60, v61, v62
    v_max_u32 v13, v13, v63
    v_cmp_eq_u32 vcc, -1, v13
    s_nop 0
    s_cmp_eq_u64 vcc, 0
    s_cbranch_scc0 L_slow7
L_ok7:
    v_lshlrev_b32 v56, 16, v60
    v_and_b32 v57, 0xffff0000, v60
    v_lshlrev_b32 v58, 16, v61
    v_and_b32 v59, 0xffff0000, v61
    v_lshlrev_b32 v60, 16, v62
    v_and_b32 v61, 0xffff0000, v62
    v_lshlrev_b32 v62, 16, v63
    v_and_b32 v63, 0xffff0000, v63
    v_pk_add_f32 v[232:233], v[232:233], v[56:57]
    v_pk_add_f32 v[234:235], v[234:235], v[58:59]
    s_mov_b32 s55, 14336
    buffer_store_dwordx4 v[232:235], v29, s[36:39], s55 offen sc1
    v_pk_add_f32 v[236:237], v[236:237], v[60:61]
    v_pk_add_f32 v[238:239], v[238:239], v[62:63]
    s_mov_b32 s55, 21504
    buffer_store_dwordx4 v[236:239], v29, s[36:39], s55 offen sc1
    s_endpgm
L_slow6:
    s_mov_b32 s90, 0
L_spin6:
    buffer_load_dwordx4 v[52:55], v252, s[32:35], s84 offen sc1
    s_add_u32 s90, s90, 1
    s_waitcnt vmcnt(0)
    s_cmp_ge_u32 s90, 524288
    s_cbranch_scc1 L_giveup6
    v_max3_u32 v13, v52, v53, v54
    v_max_u32 v13, v13, v55
    v_cmp_eq_u32 vcc, -1, v13
    s_nop 0
    s_cmp_eq_u64 vcc, 0
    s_cbranch_scc0 L_spin6
L_giveup6:
    s_nop 1
    s_branch L_ok6
L_slow7:
    s_mov_b32 s90, 0
L_spin7:
    buffer_load_dwordx4 v[60:63], v252, s[32:35], s84 offen offset:1024 sc1
    s_add_u32 s90, s90, 1
    s_waitcnt vmcnt(0)
    s_cmp_ge_u32 s90, 524288
    s_cbranch_scc1 L_giveup7
    v_max3_u32 v13, v60, v61, v62
    v_max_u32 v13, v13, v63
    v_cmp_eq_u32 vcc, -1, v13
    s_nop 0
    s_cmp_eq_u64 vcc, 0
    s_cbranch_scc0 L_spin7
L_giveup7:
    s_nop 1
    s_branch L_ok7
L_last:
    s_endpgm
.section .rodata,"a"
.p2align 6
.amdhsa_kernel gated_mix__ssm_conv_s5__glu_gated_bilinear__prompt_kernel
  .amdhsa_next_free_vgpr 512
  .amdhsa_next_free_sgpr 102
  .amdhsa_accum_offset 256
  .amdhsa_group_segment_fixed_size 0
  .amdhsa_kernarg_size 136
  .amdhsa_user_sgpr_count 2
  .amdhsa_user_sgpr_kernarg_segment_ptr 1
  .amdhsa_system_sgpr_workgroup_id_x 1
  .amdhsa_float_denorm_mode_32 3
.end_amdhsa_kernel
```
